```python
import torch

def _softmax(x, axis=-1):
    return torch.softmax(x, dim=axis)
def _gelu(x):
    return torch.nn.functional.gelu(x, approximate="tanh")
def _silu(x):
    return torch.nn.functional.silu(x)
def _sigmoid(x):
    return torch.sigmoid(x)
def _layernorm(x, axis=-1, eps=1e-5):
    m = x.mean(dim=axis, keepdim=True)
    v = x.var(dim=axis, keepdim=True, unbiased=False)
    return (x - m) / torch.sqrt(v + eps)
def _scatter_add(tgt, idx, src, axis=0):
    return tgt.clone().index_add_(axis, idx, src)
def _segment_sum(src, seg, n):
    out = torch.zeros((n,) + src.shape[1:], dtype=src.dtype)
    return out.index_add_(0, seg, src)
def _pad(x, pw):
    flat = tuple(v for pair in reversed(pw) for v in pair)
    return torch.nn.functional.pad(x, flat)

kernel_name = 'parallel_sum__ssm_conv_s5__dense_activation_relu__prompt'

def setup_inputs():

    _w = (lambda a: (lambda t: t.to(torch.bfloat16) if t.is_floating_point() else t)(torch.as_tensor(a)))
    def _A_setup():
        B, S, D = 1, 2048, 512
        P = D
        Lambda_re = -0.5 * (lambda _x: torch.exp(torch.as_tensor(_x)))((lambda *s: torch.randn(*s, dtype=torch.bfloat16) * 0.8)(P))
        Lambda_im = (lambda *s: torch.randn(*s, dtype=torch.bfloat16) * 0.8)(P) * 1.0
        B_re = (lambda *s: torch.randn(*s, dtype=torch.bfloat16) * 0.8)(P, D) * (D ** -0.5)
        B_im = (lambda *s: torch.randn(*s, dtype=torch.bfloat16) * 0.8)(P, D) * (D ** -0.5)
        C_re = (lambda *s: torch.randn(*s, dtype=torch.bfloat16) * 0.8)(D, P) * (P ** -0.5)
        C_im = (lambda *s: torch.randn(*s, dtype=torch.bfloat16) * 0.8)(D, P) * (P ** -0.5)
        log_dt = (lambda *s: torch.randn(*s, dtype=torch.bfloat16) * 0.8)(P) * 0.3 - 2.0
        Dskip = (lambda *s: torch.randn(*s, dtype=torch.bfloat16) * 0.8)(D)
        return {
            "x": _w((lambda *s: torch.randn(*s, dtype=torch.bfloat16) * 0.05)(B, S, D)),
            "Lambda_re": _w(Lambda_re),
            "Lambda_im": _w(Lambda_im),
            "B_re": _w(B_re),
            "B_im": _w(B_im),
            "C_re": _w(C_re),
            "C_im": _w(C_im),
            "log_dt": _w(log_dt),
            "Dskip": _w(Dskip),
        }
    _A_in = _A_setup()

    def _B_setup():
        B, S, D, Dff = 1, 2048, 512, 1792
        return {
            "x": _w((lambda *s: torch.randn(*s, dtype=torch.bfloat16) * 0.05)(B, S, D)),
            "w1": _w((lambda *s: torch.randn(*s, dtype=torch.bfloat16) * 0.05)(D, Dff)),
            "w2": _w((lambda *s: torch.randn(*s, dtype=torch.bfloat16) * 0.05)(Dff, D)),
        }
    _B_in = _B_setup()

    return {
        "A_x": _A_in["x"],
        "A_Lambda_re": _A_in["Lambda_re"],
        "A_Lambda_im": _A_in["Lambda_im"],
        "A_B_re": _A_in["B_re"],
        "A_B_im": _A_in["B_im"],
        "A_C_re": _A_in["C_re"],
        "A_C_im": _A_in["C_im"],
        "A_log_dt": _A_in["log_dt"],
        "A_Dskip": _A_in["Dskip"],
        "B_x": _B_in["x"],
        "B_w1": _B_in["w1"],
        "B_w2": _B_in["w2"],
    }

def reference(A_x, A_Lambda_re, A_Lambda_im, A_B_re, A_B_im, A_C_re, A_C_im, A_log_dt, A_Dskip, B_x, B_w1, B_w2):
    def _A_ref(x, Lambda_re, Lambda_im, B_re, B_im, C_re, C_im, log_dt, Dskip):
        Bsz, L, H = x.shape
        Lam = Lambda_re + 1j * Lambda_im
        Bmat = B_re + 1j * B_im
        Cmat = C_re + 1j * C_im
        dt = torch.exp(log_dt)
        Lam_bar = torch.exp(dt * Lam)
        B_bar = ((Lam_bar - 1.0) / Lam)[:, None] * Bmat
        Bu = torch.einsum("bld,pd->blp", x + 0j, B_bar)
        h = torch.zeros_like(Bu[:, 0, :])
        hs = []
        for t in range(L):
            h = Lam_bar[None, :] * h + Bu[:, t, :]
            hs.append(h)
        hseq = torch.stack(hs, 1)
        y = 2.0 * torch.einsum("blp,dp->bld", hseq, Cmat).real + x * Dskip[None, None, :]
        return y

    def _B_ref(x, w1, w2):
        h = torch.einsum("bsd,df->bsf", x, w1)
        zero = torch.zeros_like(h)
        h = torch.maximum(h, zero)
        return torch.einsum("bsf,fd->bsd", h, w2)

    x = A_x
    xn = _layernorm(x, axis=-1)
    return x + _A_ref(xn, A_Lambda_re, A_Lambda_im, A_B_re, A_B_im, A_C_re, A_C_im, A_log_dt, A_Dskip) + _B_ref(xn, B_w1, B_w2)
```

```asm
; @launch grid=(256,1,1) block=(256,1,1) lds=163840
.amdgcn_target "amdgcn-amd-amdhsa--gfx950"
.text
.globl parallel_sum__ssm_conv_s5__dense_activation_relu__prompt_kernel
.p2align 8
.type parallel_sum__ssm_conv_s5__dense_activation_relu__prompt_kernel,@function
parallel_sum__ssm_conv_s5__dense_activation_relu__prompt_kernel:
L_start:
    s_load_dwordx16 s[16:31], s[0:1], 0
    s_load_dwordx4 s[36:39], s[0:1], 80
    s_lshr_b32 s15, s2, 6
    s_cmp_ge_u32 s15, 4
    s_cbranch_scc1 L_end
    s_and_b32 s12, s2, 1
    s_and_b32 s13, s2, 6
    s_lshl1_add_u32 s7, s13, s15
    s_lshr_b32 s9, s2, 3
    s_and_b32 s9, s9, 7
    s_lshl3_add_u32 s8, s12, s9
    s_lshl4_add_u32 s97, s7, s8
    s_lshl_b32 s3, s97, 13
    s_getpc_b64 s[64:65]
L_pc:
    s_lshr_b32 s14, s2, 3
    s_lshl_b32 s14, s14, 10
    v_lshl_add_u32 v9, v0, 2, s14
    v_min_u32 v9, L_fin-L_pc-4, v9
    global_load_dword v10, v9, s[64:65]
    v_and_b32 v1, 63, v0
    v_lshrrev_b32 v9, 6, v0
    v_lshrrev_b32 v2, 3, v1
    v_readfirstlane_b32 s4, v9
    v_and_b32 v3, 7, v1
    v_lshrrev_b32 v4, 4, v1
    v_xor_b32 v5, v3, v4
    v_lshlrev_b32 v5, 4, v5
    v_lshrrev_b32 v7, 5, v1
    v_and_b32 v8, 3, v2
    v_lshl_add_u32 v7, v7, 4, v8
    s_lshl2_add_u32 s14, s7, s4
    s_lshl_b32 s14, s14, 5
    v_add_u32 v7, s14, v7
    v_lshl_add_u32 v200, v7, 10, v5
    s_lshl_b32 s94, s4, 13
    s_mov_b32 m0, s94
    s_lshl_b32 s92, s13, 7
    s_lshl_b32 s50, 1, 21
    s_mov_b32 s51, 0x20000
    s_waitcnt lgkmcnt(0)
    s_mov_b32 s48, s16
    s_and_b32 s49, s17, 0xffff
    buffer_load_dwordx4 v200, s[48:51], s92 offen offset:0 lds
    v_xor_b32 v201, 64, v200
    v_add_u32 v201, 3072, v201
    buffer_load_dwordx4 v201, s[48:51], s92 offen offset:1024 lds
    v_add_u32 v202, 6144, v200
    buffer_load_dwordx4 v202, s[48:51], s92 offen offset:2048 lds
    v_add_u32 v203, 6144, v201
    buffer_load_dwordx4 v203, s[48:51], s92 offen offset:3072 lds
    s_lshr_b32 s5, s4, 1
    s_and_b32 s6, s4, 1
    s_lshl1_add_u32 s35, s8, s6
    s_lshl_b32 s35, s35, 4
    v_add_u32 v7, s35, v2
    v_lshl_add_u32 v204, v7, 10, v5
    s_cmp_eq_u32 s5, 0
    s_cselect_b64 s[52:53], s[22:23], s[24:25]
    s_and_b32 s53, s53, 0xffff
    s_lshl_b32 s54, 1, 19
    s_mov_b32 s55, s51
    s_mov_b32 s93, s13
    s_add_u32 m0, s94, 4096
    s_mul_i32 s93, s93, 229376
    buffer_load_dwordx4 v204, s[52:55], s92 offen offset:0 lds
    v_xor_b32 v205, 64, v204
    v_add_u32 v205, 7168, v205
    buffer_load_dwordx4 v205, s[52:55], s92 offen offset:1024 lds
    s_and_b32 s15, s15, 1
    s_lshl1_add_u32 s10, s9, s15
    s_add_u32 s14, s9, 6
    s_cmp_lt_u32 s9, 6
    s_cselect_b32 s10, s10, s14
    s_cselect_b32 s62, 1835008, 0
    s_lshl_b32 s14, s4, 4
    v_add_u32 v7, s14, v2
    v_mul_u32_u24 v7, 3584, v7
    v_and_b32 v8, 1, v4
    v_lshlrev_b32 v8, 2, v8
    v_xor_b32 v8, v8, v3
    v_lshl_add_u32 v206, v8, 4, v7
    s_mul_i32 s15, s12, 14
    s_add_u32 s14, s15, s10
    s_lshl_b32 s14, s14, 7
    s_sub_u32 s58, 1835008, s14
    s_and_b32 s37, s37, 0xffff
    s_add_u32 s56, s36, s14
    s_addc_u32 s57, s37, 0
    s_mov_b32 s59, s51
    s_add_u32 m0, s94, 6144
    s_nop 0
    buffer_load_dwordx4 v206, s[56:59], s93 offen offset:0 lds
    v_add_u32 v207, 27648, v206
    buffer_load_dwordx4 v207, s[56:59], s93 offen offset:1024 lds
    v_lshlrev_b32 v33, 4, v1
    v_lshlrev_b32 v9, 11, v9
    v_add3_u32 v9, v9, v33, s3
    global_load_dwordx4 v[40:43], v9, s[16:17]
    global_load_dwordx4 v[44:47], v9, s[16:17] offset:1024
    s_load_dwordx2 s[44:45], s[0:1], 112
    s_load_dwordx2 s[32:33], s[0:1], 64
    s_load_dwordx2 s[40:41], s[0:1], 96
    s_xor_b32 s34, s10, 1
    s_add_u32 s14, s15, s34
    s_lshl_b32 s14, s14, 7
    s_max_u32 s62, s62, s14
    s_sub_u32 s62, s62, s14
    s_add_u32 s60, s36, s14
    s_addc_u32 s61, s37, 0
    s_mov_b32 s63, s51
    s_mov_b32 s70, 0x76543210
    s_mov_b32 s71, s70
    s_lshl_b32 s13, s13, 2
    s_lshr_b64 s[70:71], s[70:71], s13
    s_mov_b32 s11, s70
    v_lshl_add_u32 v228, v2, 10, v5
    v_lshlrev_b32 v7, 10, v2
    v_lshl_add_u32 v224, v8, 4, v7
    v_and_b32 v6, 15, v1
    v_add_lshl_u32 v11, v6, s35, 1
    v_min_u32 v15, 1, v1
    v_mul_u32_u24 v15, 6291456, v15
    s_lshl2_add_u32 s15, s97, s4
    s_waitcnt lgkmcnt(0)
    global_load_dword v16, v15, s[44:45] sc1
    global_load_ushort v12, v11, s[18:19]
    global_load_ushort v13, v11, s[20:21]
    global_load_ushort v14, v11, s[30:31]
    s_lshl_b32 s14, s9, 7
    v_lshl_add_u32 v35, v6, 3, s14
    global_load_dwordx2 v[38:39], v35, s[32:33]
    v_and_b32 v2, 31, v1
    v_lshrrev_b32 v3, 5, v1
    v_bfe_u32 v7, v2, 1, 3
    v_xor_b32 v7, v7, v3
    v_lshlrev_b32 v7, 4, v7
    v_lshl_add_u32 v233, v2, 7, v7
    s_lshl_b32 s14, s5, 5
    v_xor_b32 v7, s14, v7
    v_xor_b32 v5, s14, v233
    s_lshl_b32 s14, s5, 14
    v_add_u32 v176, s14, v5
    v_lshl_add_u32 v7, v6, 7, v7
    v_and_b32 v8, 16, v2
    v_lshl_add_u32 v7, v8, 10, v7
    s_lshl_b32 s14, s6, 13
    s_add_u32 s14, s14, 4096
    v_add_u32 v180, s14, v7
    v_xor_b32 v177, 32, v176
    v_xor_b32 v181, 32, v180
    v_xor_b32 v178, 64, v176
    v_xor_b32 v182, 64, v180
    v_xor_b32 v179, 96, v176
    v_xor_b32 v183, 96, v180
    v_lshrrev_b32 v9, 2, v6
    v_lshlrev_b32 v5, 7, v9
    v_and_b32 v7, 3, v6
    v_lshl_add_u32 v5, v7, 3, v5
    v_lshl_add_u32 v5, v8, 1, v5
    v_and_b32 v7, 8, v6
    v_lshl_add_u32 v5, v7, 3, v5
    v_lshl_add_u32 v232, v3, 9, v5
    v_lshl_add_u32 v5, v3, 10, v5
    s_lshl_b32 s14, s6, 6
    s_lshl_b32 s13, s5, 13
    s_or_b32 s14, s14, s13
    v_xor_b32 v184, s14, v5
    v_xor_b32 v185, 8192, v184
    v_xor_b32 v186, 16384, v184
    v_xor_b32 v187, 24576, v184
    s_mov_b32 s95, 0x3f803f80
    v_mov_b32 v220, 0
    v_mov_b32 v221, 0
    v_mov_b32 v48, 0
    v_mov_b32 v49, 0
    v_mov_b32 v50, 0
    v_mov_b32 v51, 0
    v_add_u32 v188, 65536, v176
    v_add_u32 v189, 65536, v177
    v_add_u32 v190, 65536, v178
    v_add_u32 v191, 65536, v179
    v_add_u32 v192, 65536, v180
    v_add_u32 v193, 65536, v181
    v_add_u32 v194, 65536, v182
    v_add_u32 v195, 65536, v183
    v_add_u32 v196, 65536, v184
    v_add_u32 v197, 65536, v185
    v_add_u32 v198, 65536, v186
    v_add_u32 v199, 65536, v187
    s_mov_b32 s88, s44
    s_and_b32 s89, s45, 0xffff
    s_mov_b32 s90, 19922944
    s_mov_b32 s91, 0x20000
    s_mov_b32 s72, s38
    s_and_b32 s73, s39, 0xffff
    s_mov_b32 s74, 1835008
    s_mov_b32 s75, 0x20000
    s_mov_b32 s84, s40
    s_and_b32 s85, s41, 0xffff
    s_mov_b32 s86, 4194304
    s_mov_b32 s87, 0x20000
    s_and_b32 s27, s27, 0xffff
    s_and_b32 s29, s29, 0xffff
    s_bitcmp1_b32 s9, 0
    s_cselect_b64 s[76:77], s[28:29], s[26:27]
    s_cselect_b64 s[80:81], s[26:27], s[28:29]
    s_mov_b32 s78, 524288
    s_mov_b32 s79, 0x20000
    s_mov_b32 s82, 524288
    s_mov_b32 s83, 0x20000
    s_mul_i32 s13, s2, 56
    s_mul_i32 s14, s6, 28
    s_add_u32 s13, s13, s14
    s_lshl_b32 s14, s2, 4
    s_cmp_eq_u32 s6, 0
    s_cselect_b32 s70, s26, s28
    s_cselect_b32 s71, s27, s29
    s_cmp_eq_u32 s5, 0
    s_cselect_b32 s13, s13, s14
    s_cselect_b32 s14, 27, 15
    s_cselect_b32 s70, s38, s70
    s_cselect_b32 s71, s39, s71
    v_min_u32 v7, s14, v1
    v_add_lshl_u32 v214, v7, s13, 7
    v_and_b32 v5, 1, v4
    v_lshl_add_u32 v32, v5, 1, v3
    s_lshl_b32 s15, s15, 5
    s_add_u32 s15, s15, 786432
    v_lshl_add_u32 v7, v3, 4, s15
    v_lshl_add_u32 v208, v2, 25, v7
    s_lshl1_add_u32 s13, s7, s12
    s_lshl_b32 s14, s13, 13
    s_add_u32 s14, s14, 524288
    s_lshl_b32 s15, s4, 3
    s_mul_i32 s13, s5, 3
    s_add_u32 m0, s94, 32768
    s_bfe_u32 s93, s11, 196612
    s_lshl_b32 s92, s93, 7
    buffer_load_dwordx4 v200, s[48:51], s92 offen offset:0 lds
    s_add_u32 s13, s13, s6
    s_lshl_b32 s13, s13, 2
    s_sub_u32 s13, s13, 8
    v_mov_b32 v7, s15
    v_mov_b32 v8, s13
    v_cmp_gt_u32 vcc, 8, v1
    s_nop 1
    v_cndmask_b32 v7, v8, v7, vcc
    v_add_u32 v7, v7, v1
    v_lshl_add_u32 v7, v7, 8, s14
    v_lshl_add_u32 v36, v4, 28, v7
    s_lshl2_add_u32 s15, s9, s4
    s_lshl_b32 s15, s15, 8
    buffer_load_dwordx4 v201, s[48:51], s92 offen offset:1024 lds
    s_add_u32 s14, s14, s15
    v_lshl_add_u32 v7, v2, 2, s14
    v_lshl_add_u32 v243, v3, 30, v7
    v_lshl_add_u32 v239, v3, 7, v7
    s_lshl4_add_u32 s13, s7, s8
    s_lshl1_add_u32 s13, s13, s6
    s_lshl_b32 s13, s13, 9
    s_add_u32 s13, s13, 262144
    v_lshl_add_u32 v7, v1, 3, s13
    v_xor_b32 v211, 0x4000, v7
    s_lshl_b32 s15, s5, 30
    v_add_u32 v209, s15, v7
    buffer_load_dwordx4 v202, s[48:51], s92 offen offset:2048 lds
    s_lshl_b32 s13, s6, 8
    v_lshl_add_u32 v8, v6, 4, s13
    s_lshl1_add_u32 s67, s7, s5
    s_sub_u32 s13, 31, s67
    s_lshl_b32 s13, s13, 9
    s_lshl_b32 s14, s8, 14
    s_add_u32 s14, s14, 1048576
    s_add_u32 s14, s14, s13
    v_add_u32 v7, s14, v8
    v_lshl_add_u32 v215, v4, 28, v7
    s_add_u32 s13, s13, 512
    v_sub_u32 v7, 3, v4
    buffer_load_dwordx4 v203, s[48:51], s92 offen offset:3072 lds
    v_lshl_add_u32 v7, v7, 12, v8
    v_add_u32 v238, s13, v7
    s_lshl_b32 s67, s67, 4
    v_cmp_eq_u32 vcc, 0, v4
    s_nop 1
    v_cndmask_b32 v239, v239, v215, vcc
    v_mul_u32_u24 v7, 24, v6
    v_add3_u32 v7, v7, v209, -16
    v_subrev_u32 v7, 240, v7
    v_cmp_eq_u32 vcc, 2, v4
    s_nop 1
    v_cndmask_b32 v239, v239, v7, vcc
    s_lshl_b32 s66, s4, 14
    s_add_u32 m0, s94, 36864
    s_mul_i32 s93, s93, 229376
    buffer_load_dwordx4 v204, s[52:55], s92 offen offset:0 lds
    s_add_u32 s66, s66, 114688
    s_and_b32 s15, s7, 1
    s_lshl2_add_u32 s13, s4, s15
    s_add_u32 s14, s13, 2
    s_min_u32 s13, s13, 12
    s_min_u32 s14, s14, 13
    s_lshl_b32 s32, s13, 13
    s_lshl_b32 s33, s14, 13
    s_xor_b32 s15, s15, 1
    s_mul_i32 s13, s5, 6
    s_add_u32 s13, s13, s15
    s_lshl2_add_u32 s14, s6, s13
    buffer_load_dwordx4 v205, s[52:55], s92 offen offset:1024 lds
    s_lshl_b32 s100, s14, 13
    s_add_u32 s13, s13, 2
    s_lshl1_add_u32 s13, s13, s6
    s_lshl_b32 s101, s13, 12
    s_and_b32 s13, s9, 1
    s_sub_u32 s13, 0, s13
    s_xor_b32 s14, s32, s33
    s_and_b32 s14, s14, s13
    s_xor_b32 s32, s32, s14
    s_xor_b32 s33, s33, s14
    s_and_b32 s13, s13, 8192
    s_xor_b32 s66, s66, s13
    s_add_u32 m0, s94, 38912
    s_nop 0
    buffer_load_dwordx4 v206, s[56:59], s93 offen offset:0 lds
    s_and_b32 s13, s9, 2
    s_lshl_b32 s14, s13, 11
    s_lshl_b32 s13, s13, 5
    v_xor_b32 v228, s13, v228
    s_xor_b32 s32, s32, s14
    s_xor_b32 s33, s33, s14
    s_xor_b32 s100, s100, s14
    s_xor_b32 s66, s66, s14
    s_mul_i32 s98, s4, 16384
    s_add_u32 s98, s98, 98304
    s_mul_i32 s99, s12, 917504
    s_lshl_b32 s14, s9, 7
    buffer_load_dwordx4 v207, s[56:59], s93 offen offset:1024 lds
    s_add_u32 s99, s99, s14
    s_lshl2_add_u32 s3, s12, s4
    s_lshl_b32 s3, s3, 7
    s_lshl_b32 s13, s9, 16
    s_add_u32 s3, s3, s13
    v_xor_b32 v229, 64, v228
    v_add_u32 v229, 7168, v229
    v_add_u32 v230, 14336, v228
    v_add_u32 v231, 14336, v229
    v_add_u32 v225, 7168, v224
    v_add_u32 v226, 14336, v224
    v_add_u32 v227, 21504, v224
    s_waitcnt vmcnt(15)
    s_barrier
    ds_read_b128 v[128:131], v180 offset:0
    ds_read_b128 a[0:3], v176 offset:0
    ds_read_b128 a[4:7], v176 offset:8192
    ds_read_b64_tr_b16 v[132:133], v184 offset:6144
    ds_read_b64_tr_b16 v[134:135], v184 offset:6656
    ds_read_b128 v[136:139], v181 offset:0
    ds_read_b128 a[8:11], v177 offset:0
    ds_read_b128 a[12:15], v177 offset:8192
    ds_read_b64_tr_b16 v[140:141], v185 offset:6144
    ds_read_b64_tr_b16 v[142:143], v185 offset:6656
    s_waitcnt lgkmcnt(5)
    v_mfma_f32_32x32x16_bf16 v[96:111], v[132:135], a[0:3], 0
    ds_read_b128 v[144:147], v182 offset:0
    ds_read_b128 a[16:19], v178 offset:0
    s_add_u32 m0, s94, 65536
    s_bfe_u32 s93, s11, 196616
    s_lshl_b32 s92, s93, 7
    buffer_load_dwordx4 v200, s[48:51], s92 offen offset:0 lds
    v_mfma_f32_32x32x16_bf16 v[112:127], v[132:135], a[4:7], 0
    ds_read_b128 a[20:23], v178 offset:8192
    buffer_load_dwordx4 v201, s[48:51], s92 offen offset:1024 lds
    buffer_load_dwordx4 v202, s[48:51], s92 offen offset:2048 lds
    buffer_load_dwordx4 v203, s[48:51], s92 offen offset:3072 lds
    v_and_b32 v7, 4, v1
    v_mfma_f32_32x32x16_bf16 v[64:79], a[0:3], v[128:131], 0
    ds_read_b64_tr_b16 v[148:149], v186 offset:6144
    s_add_u32 m0, s94, 69632
    s_mul_i32 s93, s93, 229376
    buffer_load_dwordx4 v204, s[52:55], s92 offen offset:0 lds
    buffer_load_dwordx4 v205, s[52:55], s92 offen offset:1024 lds
    v_mfma_f32_32x32x16_bf16 v[80:95], a[4:7], v[128:131], 0
    ds_read_b64_tr_b16 v[150:151], v186 offset:6656
    s_add_u32 m0, s94, 71680
    s_nop 0
    buffer_load_dwordx4 v206, s[56:59], s93 offen offset:0 lds
    buffer_load_dwordx4 v207, s[56:59], s93 offen offset:1024 lds
    v_and_b32 v8, 35, v1
    s_waitcnt lgkmcnt(5)
    v_mfma_f32_32x32x16_bf16 v[96:111], v[140:143], a[8:11], v[96:111]
    ds_read_b128 v[152:155], v183 offset:0
    ds_read_b128 a[24:27], v179 offset:0
    v_lshl_add_u32 v7, v7, 2, v8
    v_and_b32 v8, 24, v1
    v_lshrrev_b32 v8, 1, v8
    v_mfma_f32_32x32x16_bf16 v[112:127], v[140:143], a[12:15], v[112:127]
    ds_read_b128 a[28:31], v179 offset:8192
    v_add_u32 v37, v7, v8
    s_lshl1_add_u32 s14, s7, s5
    s_lshl_b32 s14, s14, 10
    s_add_u32 s14, s14, 786432
    v_mfma_f32_32x32x16_bf16 v[64:79], a[8:11], v[136:139], v[64:79]
    ds_read_b64_tr_b16 v[156:157], v187 offset:6144
    v_lshl_add_u32 v210, v37, 4, s14
    v_and_b32 v7, 3, v6
    v_lshl_add_u32 v7, v9, 3, v7
    v_lshl_add_u32 v7, v3, 2, v7
    v_mfma_f32_32x32x16_bf16 v[80:95], a[12:15], v[136:139], v[80:95]
    ds_read_b64_tr_b16 v[158:159], v187 offset:6656
    v_and_b32 v8, 16, v2
    v_lshl_add_u32 v7, v8, 1, v7
    v_lshlrev_b32 v218, 2, v7
    v_lshl_add_u32 v213, v1, 3, s94
    v_dot2c_f32_bf16 v220, s95, v128
    v_dot2c_f32_bf16 v221, s95, v132
    v_dot2c_f32_bf16 v220, s95, v129
    v_dot2c_f32_bf16 v221, s95, v133
    v_dot2c_f32_bf16 v220, s95, v130
    v_dot2c_f32_bf16 v221, s95, v134
    v_dot2c_f32_bf16 v220, s95, v131
    v_dot2c_f32_bf16 v221, s95, v135
    s_waitcnt lgkmcnt(5)
    v_dot2c_f32_bf16 v220, s95, v144
    v_dot2c_f32_bf16 v221, s95, v148
    v_dot2c_f32_bf16 v220, s95, v145
    v_dot2c_f32_bf16 v221, s95, v149
    v_dot2c_f32_bf16 v220, s95, v146
    v_dot2c_f32_bf16 v221, s95, v150
    v_dot2c_f32_bf16 v220, s95, v147
    v_dot2c_f32_bf16 v221, s95, v151
    s_waitcnt lgkmcnt(0) vmcnt(8)
    s_barrier
    global_load_dword v10, v214, s[70:71] offset:0
    buffer_load_dword v219, v239, s[88:91], 0 offen
    v_mfma_f32_32x32x16_bf16 v[96:111], v[148:151], a[16:19], v[96:111]
    ds_read_b128 v[128:131], v180 offset:32768
    ds_read_b128 a[32:35], v176 offset:32768
    s_add_u32 m0, s94, 0
    s_bfe_u32 s93, s11, 196620
    s_lshl_b32 s92, s93, 7
    buffer_load_dwordx4 v200, s[48:51], s92 offen offset:0 lds
    v_mfma_f32_32x32x16_bf16 v[112:127], v[148:151], a[20:23], v[112:127]
    ds_read_b128 a[36:39], v176 offset:40960
    v_xor_b32 v212, 16384, v213
    s_lshl1_add_u32 s13, s7, s12
    s_lshl1_add_u32 s14, s13, s5
    s_mul_i32 s14, s14, 180224
    v_mfma_f32_32x32x16_bf16 v[64:79], a[16:19], v[144:147], v[64:79]
    ds_read_b64_tr_b16 v[132:133], v184 offset:38912
    buffer_load_dwordx4 v201, s[48:51], s92 offen offset:1024 lds
    s_add_u32 s14, s14, 8388608
    s_lshl1_add_u32 s13, s13, s12
    s_mul_i32 s65, s13, 180224
    v_mfma_f32_32x32x16_bf16 v[80:95], a[20:23], v[144:147], v[80:95]
    ds_read_b64_tr_b16 v[134:135], v184 offset:39424
    s_xor_b32 s13, s13, 1
    s_mul_i32 s64, s13, 180224
    s_add_u32 s64, s64, 8388608
    s_add_u32 s65, s65, 8388608
    v_dot2c_f32_bf16 v48, s95, v40
    v_dot2c_f32_bf16 v49, s95, v44
    v_dot2c_f32_bf16 v50, v40, v40
    v_dot2c_f32_bf16 v51, v44, v44
    v_dot2c_f32_bf16 v48, s95, v41
    v_dot2c_f32_bf16 v49, s95, v45
    v_dot2c_f32_bf16 v50, v41, v41
    v_dot2c_f32_bf16 v51, v45, v45
    v_dot2c_f32_bf16 v48, s95, v42
    v_dot2c_f32_bf16 v49, s95, v46
    v_dot2c_f32_bf16 v50, v42, v42
    v_dot2c_f32_bf16 v51, v46, v46
    v_dot2c_f32_bf16 v48, s95, v43
    v_dot2c_f32_bf16 v49, s95, v47
    v_dot2c_f32_bf16 v50, v43, v43
    v_dot2c_f32_bf16 v51, v47, v47
    v_mfma_f32_32x32x16_bf16 v[96:111], v[156:159], a[24:27], v[96:111]
    ds_read_b128 v[136:139], v181 offset:32768
    ds_read_b128 a[40:43], v177 offset:32768
    buffer_load_dwordx4 v202, s[48:51], s92 offen offset:2048 lds
    v_mul_u32_u24 v0, 0xb5297b, v1
    v_add_u32 v0, 0x9e3779b9, v0
    v_mfma_f32_32x32x16_bf16 v[112:127], v[156:159], a[28:31], v[112:127]
    ds_read_b128 a[44:47], v177 offset:40960
    v_add_u32 v0, v0, v16
    v_readlane_b32 s97, v16, 1
    v_readfirstlane_b32 s96, v0
    v_permlane32_swap_b32 v48, v49
    v_mfma_f32_32x32x16_bf16 v[64:79], a[24:27], v[152:155], v[64:79]
    ds_read_b64_tr_b16 v[140:141], v185 offset:38912
    buffer_load_dwordx4 v203, s[48:51], s92 offen offset:3072 lds
    v_permlane32_swap_b32 v50, v51
    s_add_u32 s96, s96, s97
    v_add_f32 v48, v48, v49
    v_mfma_f32_32x32x16_bf16 v[80:95], a[28:31], v[152:155], v[80:95]
    ds_read_b64_tr_b16 v[142:143], v185 offset:39424
    v_add_f32 v50, v50, v51
    s_or_b32 s96, s96, 1
    v_mov_b32 v54, s96
    v_permlane16_swap_b32 v48, v50
    s_waitcnt lgkmcnt(5)
    v_mfma_f32_32x32x16_bf16 v[96:111], v[132:135], a[32:35], v[96:111]
    ds_read_b128 v[144:147], v182 offset:32768
    ds_read_b128 a[48:51], v178 offset:32768
    s_add_u32 m0, s94, 4096
    s_mul_i32 s93, s93, 229376
    buffer_load_dwordx4 v204, s[52:55], s92 offen offset:0 lds
    v_mfma_f32_32x32x16_bf16 v[112:127], v[132:135], a[36:39], v[112:127]
    ds_read_b128 a[52:55], v178 offset:40960
    v_add_f32 v48, v48, v50
    v_mov_b32 v251, s96
    s_nop 0
    v_add_f32_dpp v48, v48, v48 row_ror:8 row_mask:0xf bank_mask:0xf
    s_nop 1
    v_add_f32_dpp v48, v48, v48 row_ror:4 row_mask:0xf bank_mask:0xf
    v_mfma_f32_32x32x16_bf16 v[64:79], a[32:35], v[128:131], v[64:79]
    ds_read_b64_tr_b16 v[148:149], v186 offset:38912
    buffer_load_dwordx4 v205, s[52:55], s92 offen offset:1024 lds
    v_add_f32_dpp v48, v48, v48 row_ror:2 row_mask:0xf bank_mask:0xf
    s_nop 1
    v_add_f32_dpp v48, v48, v48 row_ror:1 row_mask:0xf bank_mask:0xf
    v_mov_b32 v49, v48
    v_mfma_f32_32x32x16_bf16 v[80:95], a[36:39], v[128:131], v[80:95]
    ds_read_b64_tr_b16 v[150:151], v186 offset:39424
    v_permlane16_swap_b32 v48, v49
    v_mul_f32 v48, 0x3b000000, v48
    v_mul_f32 v49, 0x3b000000, v49
    v_fma_f32 v49, -v48, v48, v49
    s_waitcnt lgkmcnt(5)
    v_mfma_f32_32x32x16_bf16 v[96:111], v[140:143], a[40:43], v[96:111]
    ds_read_b128 v[152:155], v183 offset:32768
    ds_read_b128 a[56:59], v179 offset:32768
    s_add_u32 m0, s94, 6144
    s_nop 0
    buffer_load_dwordx4 v206, s[56:59], s93 offen offset:0 lds
    v_max_f32 v49, 0, v49
    v_mfma_f32_32x32x16_bf16 v[112:127], v[140:143], a[44:47], v[112:127]
    ds_read_b128 a[60:63], v179 offset:40960
    v_cvt_pk_bf16_f32 v49, v49, v49
    v_lshlrev_b32 v49, 16, v49
    v_add_f32 v49, 0x3727c5ac, v49
    v_cvt_pk_bf16_f32 v49, v49, v49
    v_mfma_f32_32x32x16_bf16 v[64:79], a[40:43], v[136:139], v[64:79]
    ds_read_b64_tr_b16 v[156:157], v187 offset:38912
    buffer_load_dwordx4 v207, s[56:59], s93 offen offset:1024 lds
    v_lshlrev_b32 v49, 16, v49
    v_sqrt_f32 v49, v49
    v_mfma_f32_32x32x16_bf16 v[80:95], a[44:47], v[136:139], v[80:95]
    ds_read_b64_tr_b16 v[158:159], v187 offset:39424
    v_cvt_pk_bf16_f32 v53, -v48, -v48
    v_cvt_pk_bf16_f32 v49, v49, v49
    v_lshlrev_b32 v49, 16, v49
    s_lshl_b32 s13, s6, 12
    v_dot2c_f32_bf16 v220, s95, v128
    v_dot2c_f32_bf16 v221, s95, v132
    v_dot2c_f32_bf16 v220, s95, v129
    v_dot2c_f32_bf16 v221, s95, v133
    v_dot2c_f32_bf16 v220, s95, v130
    v_dot2c_f32_bf16 v221, s95, v134
    v_dot2c_f32_bf16 v220, s95, v131
    v_dot2c_f32_bf16 v221, s95, v135
    s_waitcnt lgkmcnt(5)
    v_dot2c_f32_bf16 v220, s95, v144
    v_dot2c_f32_bf16 v221, s95, v148
    v_dot2c_f32_bf16 v220, s95, v145
    v_dot2c_f32_bf16 v221, s95, v149
    v_dot2c_f32_bf16 v220, s95, v146
    v_dot2c_f32_bf16 v221, s95, v150
    v_dot2c_f32_bf16 v220, s95, v147
    v_dot2c_f32_bf16 v221, s95, v151
    s_waitcnt lgkmcnt(0) vmcnt(10)
    s_barrier
    v_mfma_f32_32x32x16_bf16 v[96:111], v[148:151], a[48:51], v[96:111]
    ds_read_b128 v[128:131], v192 offset:0
    ds_read_b128 a[64:67], v188 offset:0
    s_add_u32 m0, s94, 32768
    s_bfe_u32 s93, s11, 196624
    s_lshl_b32 s92, s93, 7
    buffer_load_dwordx4 v200, s[48:51], s92 offen offset:0 lds
    v_mfma_f32_32x32x16_bf16 v[112:127], v[148:151], a[52:55], v[112:127]
    ds_read_b128 a[68:71], v188 offset:8192
    v_rcp_f32 v52, v49
    buffer_store_dwordx4 v[52:55], v208, s[88:91], 0 offen sc1
    s_add_u32 s13, s13, s14
    v_mfma_f32_32x32x16_bf16 v[64:79], a[48:51], v[144:147], v[64:79]
    ds_read_b64_tr_b16 v[132:133], v196 offset:6144
    buffer_load_dwordx4 v201, s[48:51], s92 offen offset:1024 lds
    s_lshl_b32 s15, s10, 13
    s_add_u32 s15, s15, s13
    v_add_u32 v216, s15, v33
    v_mfma_f32_32x32x16_bf16 v[80:95], a[52:55], v[144:147], v[80:95]
    ds_read_b64_tr_b16 v[134:135], v196 offset:6656
    s_lshl_b32 s15, s34, 13
    s_add_u32 s15, s15, s13
    s_min_u32 s13, s62, 1
    s_sub_u32 s13, 1, s13
    v_mfma_f32_32x32x16_bf16 v[96:111], v[156:159], a[56:59], v[96:111]
    ds_read_b128 v[136:139], v193 offset:0
    ds_read_b128 a[72:75], v189 offset:0
    buffer_load_dwordx4 v202, s[48:51], s92 offen offset:2048 lds
    s_lshl_b32 s13, s13, 30
    s_add_u32 s15, s15, s13
    v_mfma_f32_32x32x16_bf16 v[112:127], v[156:159], a[60:63], v[112:127]
    ds_read_b128 a[76:79], v189 offset:8192
    v_add_u32 v217, s15, v33
    s_lshr_b32 s13, s9, 1
    s_and_b32 s15, s9, 1
    s_lshl2_add_u32 s13, s13, s15
    v_mfma_f32_32x32x16_bf16 v[64:79], a[56:59], v[152:155], v[64:79]
    ds_read_b64_tr_b16 v[140:141], v197 offset:6144
    buffer_load_dwordx4 v203, s[48:51], s92 offen offset:3072 lds
    s_lshl1_add_u32 s13, s13, s6
    s_add_u32 s13, s13, 56
    s_lshl_b32 s13, s13, 11
    v_mfma_f32_32x32x16_bf16 v[80:95], a[60:63], v[152:155], v[80:95]
    ds_read_b64_tr_b16 v[142:143], v197 offset:6656
    s_add_u32 s13, s13, s14
    v_add_u32 v242, s13, v33
    s_lshl1_add_u32 s13, s7, s12
    s_lshl2_add_u32 s13, s13, s4
    s_waitcnt lgkmcnt(5)
    v_mfma_f32_32x32x16_bf16 v[96:111], v[132:135], a[64:67], v[96:111]
    ds_read_b128 v[144:147], v194 offset:0
    ds_read_b128 a[80:83], v190 offset:0
    s_add_u32 m0, s94, 36864
    s_mul_i32 s93, s93, 229376
    buffer_load_dwordx4 v204, s[52:55], s92 offen offset:0 lds
    v_mfma_f32_32x32x16_bf16 v[112:127], v[132:135], a[68:71], v[112:127]
    ds_read_b128 a[84:87], v190 offset:8192
    s_lshl_b32 s13, s13, 4
    v_add_u32 v7, s13, v4
    v_and_b32 v8, 3, v6
    v_lshl_add_u32 v34, v8, 2, v7
    v_mfma_f32_32x32x16_bf16 v[64:79], a[64:67], v[128:131], v[64:79]
    ds_read_b64_tr_b16 v[148:149], v198 offset:6144
    buffer_load_dwordx4 v205, s[52:55], s92 offen offset:1024 lds
    v_lshlrev_b32 v34, 4, v34
    v_add_u32 v34, 786432, v34
    v_lshl_add_u32 v18, v7, 10, v35
    v_mfma_f32_32x32x16_bf16 v[80:95], a[68:71], v[128:131], v[80:95]
    ds_read_b64_tr_b16 v[150:151], v198 offset:6656
    v_lshlrev_b32 v19, 1, v18
    s_lshl4_add_u32 s13, s7, s8
    s_lshl2_add_u32 s13, s13, s4
    s_lshl_b32 s13, s13, 12
    s_waitcnt lgkmcnt(5)
    v_mfma_f32_32x32x16_bf16 v[96:111], v[140:143], a[72:75], v[96:111]
    ds_read_b128 v[152:155], v195 offset:0
    ds_read_b128 a[88:91], v191 offset:0
    s_add_u32 m0, s94, 38912
    s_nop 0
    buffer_load_dwordx4 v206, s[56:59], s93 offen offset:0 lds
    s_add_u32 s13, s13, 2097152
    v_mfma_f32_32x32x16_bf16 v[112:127], v[140:143], a[76:79], v[112:127]
    ds_read_b128 a[92:95], v191 offset:8192
    v_add_u32 v244, s13, v33
    v_xor_b32 v245, 0x20000, v244
    v_and_b32 v7, 7, v2
    v_xor_b32 v7, v7, v3
    v_mfma_f32_32x32x16_bf16 v[64:79], a[72:75], v[136:139], v[64:79]
    ds_read_b64_tr_b16 v[156:157], v199 offset:6144
    buffer_load_dwordx4 v207, s[56:59], s93 offen offset:1024 lds
    v_lshlrev_b32 v7, 4, v7
    v_and_b32 v8, 31, v37
    v_lshl_add_u32 v7, v8, 8, v7
    v_mfma_f32_32x32x16_bf16 v[80:95], a[76:79], v[136:139], v[80:95]
    ds_read_b64_tr_b16 v[158:159], v199 offset:6656
    v_add_u32 v246, s98, v7
    v_xor_b32 v247, 32, v246
    v_xor_b32 v248, 64, v246
    v_xor_b32 v249, 96, v246
    s_add_u32 m0, s98, 0
    s_lshl3_add_u32 s92, s32, s99
    buffer_load_dwordx4 v224, s[72:75], s92 offen offset:0 lds
    v_dot2c_f32_bf16 v220, s95, v128
    v_dot2c_f32_bf16 v221, s95, v132
    v_dot2c_f32_bf16 v220, s95, v129
    v_dot2c_f32_bf16 v221, s95, v133
    v_dot2c_f32_bf16 v220, s95, v130
    v_dot2c_f32_bf16 v221, s95, v134
    v_dot2c_f32_bf16 v220, s95, v131
    v_dot2c_f32_bf16 v221, s95, v135
    s_waitcnt lgkmcnt(5)
    v_dot2c_f32_bf16 v220, s95, v144
    v_dot2c_f32_bf16 v221, s95, v148
    v_dot2c_f32_bf16 v220, s95, v145
    v_dot2c_f32_bf16 v221, s95, v149
    v_dot2c_f32_bf16 v220, s95, v146
    v_dot2c_f32_bf16 v221, s95, v150
    v_dot2c_f32_bf16 v220, s95, v147
    v_dot2c_f32_bf16 v221, s95, v151
    buffer_load_dwordx4 v225, s[72:75], s92 offen offset:1024 lds
    s_waitcnt lgkmcnt(0) vmcnt(11)
    s_barrier
    v_mfma_f32_32x32x16_bf16 v[96:111], v[148:151], a[80:83], v[96:111]
    ds_read_b128 v[128:131], v180 offset:0
    ds_read_b128 a[96:99], v176 offset:0
    s_add_u32 m0, s94, 65536
    s_bfe_u32 s93, s11, 196628
    s_lshl_b32 s92, s93, 7
    buffer_load_dwordx4 v200, s[48:51], s92 offen offset:0 lds
    v_mfma_f32_32x32x16_bf16 v[112:127], v[148:151], a[84:87], v[112:127]
    ds_read_b128 a[100:103], v176 offset:8192
    v_xor_b32 v7, v6, v4
    v_lshlrev_b32 v7, 4, v7
    v_lshl_add_u32 v7, v4, 8, v7
    s_lshl_b32 s13, s4, 12
    v_mfma_f32_32x32x16_bf16 v[64:79], a[80:83], v[144:147], v[64:79]
    ds_read_b64_tr_b16 v[132:133], v184 offset:6144
    buffer_load_dwordx4 v201, s[48:51], s92 offen offset:1024 lds
    s_lshl_b32 s14, s6, 6
    s_or_b32 s13, s13, s14
    s_add_u32 s13, s13, 98304
    v_mfma_f32_32x32x16_bf16 v[80:95], a[84:87], v[144:147], v[80:95]
    ds_read_b64_tr_b16 v[134:135], v184 offset:6656
    v_xor_b32 v250, s13, v7
    v_and_b32 v7, 2, v6
    v_and_b32 v8, 1, v6
    v_lshl_add_u32 v7, v7, 1, v8
    v_mfma_f32_32x32x16_bf16 v[96:111], v[156:159], a[88:91], v[96:111]
    ds_read_b128 v[136:139], v181 offset:0
    ds_read_b128 a[104:107], v177 offset:0
    buffer_load_dwordx4 v202, s[48:51], s92 offen offset:2048 lds
    v_and_b32 v8, 4, v6
    v_lshrrev_b32 v8, 1, v8
    v_mfma_f32_32x32x16_bf16 v[112:127], v[156:159], a[92:95], v[112:127]
    ds_read_b128 a[108:111], v177 offset:8192
    v_or_b32 v7, v7, v8
    v_lshlrev_b32 v8, 1, v32
    v_xor_b32 v7, v7, v8
    v_lshlrev_b32 v7, 4, v7
    v_mfma_f32_32x32x16_bf16 v[64:79], a[88:91], v[152:155], v[64:79]
    ds_read_b64_tr_b16 v[140:141], v185 offset:6144
    buffer_load_dwordx4 v203, s[48:51], s92 offen offset:3072 lds
    v_lshl_add_u32 v7, v6, 7, v7
    s_add_u32 s13, s94, 69632
    v_add_u32 v252, s13, v7
    v_mfma_f32_32x32x16_bf16 v[80:95], a[92:95], v[152:155], v[80:95]
    ds_read_b64_tr_b16 v[142:143], v185 offset:6656
    v_xor_b32 v253, 16, v252
    v_and_b32 v5, 1, v6
    v_and_b32 v8, 16, v2
    v_lshl_add_u32 v5, v5, 5, v8
    s_waitcnt lgkmcnt(5)
    v_mfma_f32_32x32x16_bf16 v[96:111], v[132:135], a[96:99], v[96:111]
    ds_read_b128 v[144:147], v182 offset:0
    ds_read_b128 a[112:115], v178 offset:0
    s_add_u32 m0, s94, 69632
    s_mul_i32 s93, s93, 229376
    buffer_load_dwordx4 v204, s[52:55], s92 offen offset:0 lds
    v_mfma_f32_32x32x16_bf16 v[112:127], v[132:135], a[100:103], v[112:127]
    ds_read_b128 a[116:119], v178 offset:8192
    v_and_b32 v8, 2, v6
    v_lshl_add_u32 v5, v8, 2, v5
    v_and_b32 v7, 2, v9
    v_and_b32 v8, 1, v9
    v_mfma_f32_32x32x16_bf16 v[64:79], a[96:99], v[128:131], v[64:79]
    ds_read_b64_tr_b16 v[148:149], v186 offset:6144
    buffer_load_dwordx4 v205, s[52:55], s92 offen offset:1024 lds
    v_lshl_add_u32 v7, v7, 1, v8
    v_lshlrev_b32 v7, 4, v7
    v_xor_b32 v7, v7, v5
    v_mfma_f32_32x32x16_bf16 v[80:95], a[100:103], v[128:131], v[80:95]
    ds_read_b64_tr_b16 v[150:151], v186 offset:6656
    v_lshl_add_u32 v8, v3, 3, v9
    v_lshl_add_u32 v7, v8, 7, v7
    v_add_u32 v254, s13, v7
    v_lshlrev_b32 v14, 16, v14
    s_waitcnt lgkmcnt(5)
    v_mfma_f32_32x32x16_bf16 v[96:111], v[140:143], a[104:107], v[96:111]
    ds_read_b128 v[152:155], v183 offset:0
    ds_read_b128 a[120:123], v179 offset:0
    s_add_u32 m0, s94, 71680
    s_nop 0
    buffer_load_dwordx4 v206, s[56:59], s93 offen offset:0 lds
    v_lshlrev_b32 v12, 16, v12
    v_mfma_f32_32x32x16_bf16 v[112:127], v[140:143], a[108:111], v[112:127]
    ds_read_b128 a[124:127], v179 offset:8192
    v_mul_f32 v14, 0x3fb8aa3b, v14
    v_lshlrev_b32 v13, 16, v13
    v_exp_f32 v14, v14
    v_mfma_f32_32x32x16_bf16 v[64:79], a[104:107], v[136:139], v[64:79]
    ds_read_b64_tr_b16 v[156:157], v187 offset:6144
    buffer_load_dwordx4 v207, s[56:59], s93 offen offset:1024 lds
    v_lshlrev_b32 v3, 4, v32
    v_cvt_pk_bf16_f32 v14, v14, v14
    v_lshlrev_b32 v14, 16, v14
    v_mfma_f32_32x32x16_bf16 v[80:95], a[108:111], v[136:139], v[80:95]
    ds_read_b64_tr_b16 v[158:159], v187 offset:6656
    v_mul_f32 v17, v14, v12
    v_mul_f32 v15, v14, v13
    v_mul_f32 v17, 0x3fb8aa3b, v17
    v_mul_f32 v15, 0x3e22f983, v15
    s_add_u32 m0, s98, 2048
    s_xor_b32 s92, s32, 2048
    s_lshl3_add_u32 s92, s92, s99
    buffer_load_dwordx4 v224, s[72:75], s92 offen offset:0 lds
    v_dot2c_f32_bf16 v220, s95, v128
    v_dot2c_f32_bf16 v221, s95, v132
    v_dot2c_f32_bf16 v220, s95, v129
    v_dot2c_f32_bf16 v221, s95, v133
    v_dot2c_f32_bf16 v220, s95, v130
    v_dot2c_f32_bf16 v221, s95, v134
    v_dot2c_f32_bf16 v220, s95, v131
    v_dot2c_f32_bf16 v221, s95, v135
    s_waitcnt lgkmcnt(5)
    v_dot2c_f32_bf16 v220, s95, v144
    v_dot2c_f32_bf16 v221, s95, v148
    v_dot2c_f32_bf16 v220, s95, v145
    v_dot2c_f32_bf16 v221, s95, v149
    v_dot2c_f32_bf16 v220, s95, v146
    v_dot2c_f32_bf16 v221, s95, v150
    v_dot2c_f32_bf16 v220, s95, v147
    v_dot2c_f32_bf16 v221, s95, v151
    buffer_load_dwordx4 v225, s[72:75], s92 offen offset:1024 lds
    s_waitcnt lgkmcnt(0) vmcnt(12)
    s_barrier
    v_mfma_f32_32x32x16_bf16 v[96:111], v[148:151], a[112:115], v[96:111]
    ds_read_b128 v[128:131], v180 offset:32768
    ds_read_b128 a[128:131], v176 offset:32768
    s_add_u32 m0, s94, 0
    s_bfe_u32 s93, s11, 196632
    s_lshl_b32 s92, s93, 7
    buffer_load_dwordx4 v200, s[48:51], s92 offen offset:0 lds
    v_mfma_f32_32x32x16_bf16 v[112:127], v[148:151], a[116:119], v[112:127]
    ds_read_b128 a[132:135], v176 offset:40960
    v_cvt_f32_u32 v3, v3
    v_sub_u32 v4, 3, v4
    v_lshlrev_b32 v4, 9, v4
    v_cvt_f32_u32 v4, v4
    v_mfma_f32_32x32x16_bf16 v[64:79], a[112:115], v[144:147], v[64:79]
    ds_read_b64_tr_b16 v[132:133], v184 offset:38912
    buffer_load_dwordx4 v201, s[48:51], s92 offen offset:1024 lds
    v_mul_f32 v6, 1.0, v15
    v_mul_f32 v5, 1.0, v17
    v_fract_f32 v6, v6
    v_mfma_f32_32x32x16_bf16 v[80:95], a[116:119], v[144:147], v[80:95]
    ds_read_b64_tr_b16 v[134:135], v184 offset:39424
    v_exp_f32 v5, v5
    v_cos_f32 v20, v6
    v_mfma_f32_32x32x16_bf16 v[96:111], v[156:159], a[120:123], v[96:111]
    ds_read_b128 v[136:139], v181 offset:32768
    ds_read_b128 a[136:139], v177 offset:32768
    buffer_load_dwordx4 v202, s[48:51], s92 offen offset:2048 lds
    v_sin_f32 v21, v6
    v_mfma_f32_32x32x16_bf16 v[112:127], v[156:159], a[124:127], v[112:127]
    ds_read_b128 a[140:143], v177 offset:40960
    v_mul_f32 v20, v20, v5
    v_mul_f32 v21, v21, v5
    v_mul_f32 v6, 0x41800000, v15
    v_mul_f32 v5, 0x41800000, v17
    v_mfma_f32_32x32x16_bf16 v[64:79], a[120:123], v[152:155], v[64:79]
    ds_read_b64_tr_b16 v[140:141], v185 offset:38912
    buffer_load_dwordx4 v203, s[48:51], s92 offen offset:3072 lds
    v_fract_f32 v6, v6
    v_exp_f32 v5, v5
    v_mfma_f32_32x32x16_bf16 v[80:95], a[124:127], v[152:155], v[80:95]
    ds_read_b64_tr_b16 v[142:143], v185 offset:39424
    v_cos_f32 v22, v6
    v_sin_f32 v23, v6
    s_waitcnt lgkmcnt(5)
    v_mfma_f32_32x32x16_bf16 v[96:111], v[132:135], a[128:131], v[96:111]
    ds_read_b128 v[144:147], v182 offset:32768
    ds_read_b128 a[144:147], v178 offset:32768
    s_add_u32 m0, s94, 4096
    s_mul_i32 s93, s93, 229376
    buffer_load_dwordx4 v204, s[52:55], s92 offen offset:0 lds
    v_mfma_f32_32x32x16_bf16 v[112:127], v[132:135], a[132:135], v[112:127]
    ds_read_b128 a[148:151], v178 offset:40960
    v_mul_f32 v22, v22, v5
    v_mul_f32 v23, v23, v5
    v_mul_f32 v6, 0x42800000, v15
    v_mul_f32 v5, 0x42800000, v17
    v_mfma_f32_32x32x16_bf16 v[64:79], a[128:131], v[128:131], v[64:79]
    ds_read_b64_tr_b16 v[148:149], v186 offset:38912
    buffer_load_dwordx4 v205, s[52:55], s92 offen offset:1024 lds
    v_fract_f32 v6, v6
    v_exp_f32 v5, v5
    v_mfma_f32_32x32x16_bf16 v[80:95], a[132:135], v[128:131], v[80:95]
    ds_read_b64_tr_b16 v[150:151], v186 offset:39424
    v_cos_f32 v24, v6
    v_sin_f32 v25, v6
    s_waitcnt lgkmcnt(5)
    v_mfma_f32_32x32x16_bf16 v[96:111], v[140:143], a[136:139], v[96:111]
    ds_read_b128 v[152:155], v183 offset:32768
    ds_read_b128 a[152:155], v179 offset:32768
    s_add_u32 m0, s94, 6144
    s_nop 0
    buffer_load_dwordx4 v206, s[56:59], s93 offen offset:0 lds
    v_mul_f32 v24, v24, v5
    v_mfma_f32_32x32x16_bf16 v[112:127], v[140:143], a[140:143], v[112:127]
    ds_read_b128 a[156:159], v179 offset:40960
    v_mul_f32 v25, v25, v5
    v_mul_f32 v6, v3, v15
    v_mul_f32 v5, v3, v17
    v_fract_f32 v6, v6
    v_mfma_f32_32x32x16_bf16 v[64:79], a[136:139], v[136:139], v[64:79]
    ds_read_b64_tr_b16 v[156:157], v187 offset:38912
    buffer_load_dwordx4 v207, s[56:59], s93 offen offset:1024 lds
    v_exp_f32 v5, v5
    v_mfma_f32_32x32x16_bf16 v[80:95], a[140:143], v[136:139], v[80:95]
    ds_read_b64_tr_b16 v[158:159], v187 offset:39424
    v_cos_f32 v26, v6
    v_sin_f32 v27, v6
    s_add_u32 m0, s98, 4096
    s_xor_b32 s92, s32, 4096
    s_lshl3_add_u32 s92, s92, s99
    buffer_load_dwordx4 v224, s[72:75], s92 offen offset:0 lds
    v_dot2c_f32_bf16 v220, s95, v128
    v_dot2c_f32_bf16 v221, s95, v132
    v_dot2c_f32_bf16 v220, s95, v129
    v_dot2c_f32_bf16 v221, s95, v133
    v_dot2c_f32_bf16 v220, s95, v130
    v_dot2c_f32_bf16 v221, s95, v134
    v_dot2c_f32_bf16 v220, s95, v131
    v_dot2c_f32_bf16 v221, s95, v135
    s_waitcnt lgkmcnt(5)
    v_dot2c_f32_bf16 v220, s95, v144
    v_dot2c_f32_bf16 v221, s95, v148
    v_dot2c_f32_bf16 v220, s95, v145
    v_dot2c_f32_bf16 v221, s95, v149
    v_dot2c_f32_bf16 v220, s95, v146
    v_dot2c_f32_bf16 v221, s95, v150
    v_dot2c_f32_bf16 v220, s95, v147
    v_dot2c_f32_bf16 v221, s95, v151
    buffer_load_dwordx4 v225, s[72:75], s92 offen offset:1024 lds
    s_waitcnt lgkmcnt(0) vmcnt(12)
    s_barrier
    v_mfma_f32_32x32x16_bf16 v[96:111], v[148:151], a[144:147], v[96:111]
    ds_read_b128 v[128:131], v192 offset:0
    ds_read_b128 a[160:163], v188 offset:0
    s_add_u32 m0, s94, 32768
    s_bfe_u32 s93, s11, 196636
    s_lshl_b32 s92, s93, 7
    buffer_load_dwordx4 v200, s[48:51], s92 offen offset:0 lds
    v_mfma_f32_32x32x16_bf16 v[112:127], v[148:151], a[148:151], v[112:127]
    ds_read_b128 a[164:167], v188 offset:8192
    v_mul_f32 v26, v26, v5
    v_mul_f32 v27, v27, v5
    v_mul_f32 v6, v4, v15
    v_mul_f32 v5, v4, v17
    v_mfma_f32_32x32x16_bf16 v[64:79], a[144:147], v[144:147], v[64:79]
    ds_read_b64_tr_b16 v[132:133], v196 offset:6144
    buffer_load_dwordx4 v201, s[48:51], s92 offen offset:1024 lds
    v_fract_f32 v6, v6
    v_exp_f32 v5, v5
    v_mfma_f32_32x32x16_bf16 v[80:95], a[148:151], v[144:147], v[80:95]
    ds_read_b64_tr_b16 v[134:135], v196 offset:6656
    v_cos_f32 v28, v6
    v_sin_f32 v29, v6
    v_mfma_f32_32x32x16_bf16 v[96:111], v[156:159], a[152:155], v[96:111]
    ds_read_b128 v[136:139], v193 offset:0
    ds_read_b128 a[168:171], v189 offset:0
    buffer_load_dwordx4 v202, s[48:51], s92 offen offset:2048 lds
    v_mul_f32 v28, v28, v5
    v_mul_f32 v29, v29, v5
    v_mfma_f32_32x32x16_bf16 v[112:127], v[156:159], a[156:159], v[112:127]
    ds_read_b128 a[172:175], v189 offset:8192
    v_mul_f32 v6, v12, v12
    v_fmac_f32 v6, v13, v13
    v_rcp_f32 v6, v6
    v_mfma_f32_32x32x16_bf16 v[64:79], a[152:155], v[152:155], v[64:79]
    ds_read_b64_tr_b16 v[140:141], v197 offset:6144
    buffer_load_dwordx4 v203, s[48:51], s92 offen offset:3072 lds
    v_add_f32 v5, -1.0, v20
    v_mul_f32 v30, v5, v12
    v_fmac_f32 v30, v21, v13
    v_mfma_f32_32x32x16_bf16 v[80:95], a[156:159], v[152:155], v[80:95]
    ds_read_b64_tr_b16 v[142:143], v197 offset:6656
    v_mul_f32 v31, v21, v12
    v_fma_f32 v31, -v5, v13, v31
    v_add_f32 v6, v6, v6
    v_mul_f32 v30, v30, v6
    s_waitcnt lgkmcnt(5)
    v_mfma_f32_32x32x16_bf16 v[96:111], v[132:135], a[160:163], v[96:111]
    ds_read_b128 v[144:147], v194 offset:0
    ds_read_b128 a[176:179], v190 offset:0
    s_add_u32 m0, s94, 36864
    s_mul_i32 s93, s93, 229376
    buffer_load_dwordx4 v204, s[52:55], s92 offen offset:0 lds
    v_mfma_f32_32x32x16_bf16 v[112:127], v[132:135], a[164:167], v[112:127]
    ds_read_b128 a[180:183], v190 offset:8192
    v_mul_f32 v31, v31, v6
    v_mfma_f32_32x32x16_bf16 v[64:79], a[160:163], v[128:131], v[64:79]
    ds_read_b64_tr_b16 v[148:149], v198 offset:6144
    buffer_load_dwordx4 v205, s[52:55], s92 offen offset:1024 lds
    v_mfma_f32_32x32x16_bf16 v[80:95], a[164:167], v[128:131], v[80:95]
    ds_read_b64_tr_b16 v[150:151], v198 offset:6656
    s_waitcnt lgkmcnt(5)
    v_mfma_f32_32x32x16_bf16 v[96:111], v[140:143], a[168:171], v[96:111]
    ds_read_b128 v[152:155], v195 offset:0
    ds_read_b128 a[184:187], v191 offset:0
    s_add_u32 m0, s94, 38912
    s_nop 0
    buffer_load_dwordx4 v206, s[56:59], s93 offen offset:0 lds
    v_mfma_f32_32x32x16_bf16 v[112:127], v[140:143], a[172:175], v[112:127]
    ds_read_b128 a[188:191], v191 offset:8192
    v_mfma_f32_32x32x16_bf16 v[64:79], a[168:171], v[136:139], v[64:79]
    ds_read_b64_tr_b16 v[156:157], v199 offset:6144
    buffer_load_dwordx4 v207, s[56:59], s93 offen offset:1024 lds
    buffer_load_dwordx3 v[40:42], v210, s[88:91], 0 offen sc1
    v_mfma_f32_32x32x16_bf16 v[80:95], a[172:175], v[136:139], v[80:95]
    ds_read_b64_tr_b16 v[158:159], v199 offset:6656
    s_add_u32 m0, s98, 6144
    s_xor_b32 s92, s32, 6144
    s_lshl3_add_u32 s92, s92, s99
    buffer_load_dwordx4 v224, s[72:75], s92 offen offset:0 lds
    v_dot2c_f32_bf16 v220, s95, v128
    v_dot2c_f32_bf16 v221, s95, v132
    v_dot2c_f32_bf16 v220, s95, v129
    v_dot2c_f32_bf16 v221, s95, v133
    v_dot2c_f32_bf16 v220, s95, v130
    v_dot2c_f32_bf16 v221, s95, v134
    v_dot2c_f32_bf16 v220, s95, v131
    v_dot2c_f32_bf16 v221, s95, v135
    s_waitcnt lgkmcnt(5)
    v_dot2c_f32_bf16 v220, s95, v144
    v_dot2c_f32_bf16 v221, s95, v148
    v_dot2c_f32_bf16 v220, s95, v145
    v_dot2c_f32_bf16 v221, s95, v149
    v_dot2c_f32_bf16 v220, s95, v146
    v_dot2c_f32_bf16 v221, s95, v150
    v_dot2c_f32_bf16 v220, s95, v147
    v_dot2c_f32_bf16 v221, s95, v151
    buffer_load_dwordx4 v225, s[72:75], s92 offen offset:1024 lds
    s_waitcnt lgkmcnt(0) vmcnt(13)
    s_barrier
    v_mfma_f32_32x32x16_bf16 v[96:111], v[148:151], a[176:179], v[96:111]
    ds_read_b128 v[128:131], v180 offset:0
    ds_read_b128 a[192:195], v176 offset:0
    s_add_u32 m0, s94, 65536
    s_bfe_u32 s93, s11, 196608
    s_mul_i32 s93, s93, 229376
    buffer_load_dwordx4 v206, s[60:63], s93 offen offset:0 lds
    v_mfma_f32_32x32x16_bf16 v[112:127], v[148:151], a[180:183], v[112:127]
    ds_read_b128 a[196:199], v176 offset:8192
    v_mfma_f32_32x32x16_bf16 v[64:79], a[176:179], v[144:147], v[64:79]
    ds_read_b64_tr_b16 v[132:133], v184 offset:6144
    buffer_load_dwordx4 v207, s[60:63], s93 offen offset:1024 lds
    v_mfma_f32_32x32x16_bf16 v[80:95], a[180:183], v[144:147], v[80:95]
    ds_read_b64_tr_b16 v[134:135], v184 offset:6656
    v_mfma_f32_32x32x16_bf16 v[96:111], v[156:159], a[184:187], v[96:111]
    ds_read_b128 v[136:139], v181 offset:0
    ds_read_b128 a[200:203], v177 offset:0
    s_add_u32 m0, s94, 67584
    s_bfe_u32 s93, s11, 196612
    s_mul_i32 s93, s93, 229376
    buffer_load_dwordx4 v206, s[60:63], s93 offen offset:0 lds
    v_mfma_f32_32x32x16_bf16 v[112:127], v[156:159], a[188:191], v[112:127]
    ds_read_b128 a[204:207], v177 offset:8192
    v_mfma_f32_32x32x16_bf16 v[64:79], a[184:187], v[152:155], v[64:79]
    ds_read_b64_tr_b16 v[140:141], v185 offset:6144
    buffer_load_dwordx4 v207, s[60:63], s93 offen offset:1024 lds
    v_mfma_f32_32x32x16_bf16 v[80:95], a[188:191], v[152:155], v[80:95]
    ds_read_b64_tr_b16 v[142:143], v185 offset:6656
    s_waitcnt lgkmcnt(5)
    v_mfma_f32_32x32x16_bf16 v[96:111], v[132:135], a[192:195], v[96:111]
    ds_read_b128 v[144:147], v182 offset:0
    ds_read_b128 a[208:211], v178 offset:0
    s_add_u32 m0, s94, 69632
    s_bfe_u32 s93, s11, 196616
    s_mul_i32 s93, s93, 229376
    buffer_load_dwordx4 v206, s[60:63], s93 offen offset:0 lds
    v_mfma_f32_32x32x16_bf16 v[112:127], v[132:135], a[196:199], v[112:127]
    ds_read_b128 a[212:215], v178 offset:8192
    v_mfma_f32_32x32x16_bf16 v[64:79], a[192:195], v[128:131], v[64:79]
    ds_read_b64_tr_b16 v[148:149], v186 offset:6144
    buffer_load_dwordx4 v207, s[60:63], s93 offen offset:1024 lds
    v_mfma_f32_32x32x16_bf16 v[80:95], a[196:199], v[128:131], v[80:95]
    ds_read_b64_tr_b16 v[150:151], v186 offset:6656
    s_waitcnt lgkmcnt(5)
    v_mfma_f32_32x32x16_bf16 v[96:111], v[140:143], a[200:203], v[96:111]
    ds_read_b128 v[152:155], v183 offset:0
    ds_read_b128 a[216:219], v179 offset:0
    s_add_u32 m0, s94, 71680
    s_bfe_u32 s93, s11, 196620
    s_mul_i32 s93, s93, 229376
    buffer_load_dwordx4 v206, s[60:63], s93 offen offset:0 lds
    v_mfma_f32_32x32x16_bf16 v[112:127], v[140:143], a[204:207], v[112:127]
    ds_read_b128 a[220:223], v179 offset:8192
    v_mfma_f32_32x32x16_bf16 v[64:79], a[200:203], v[136:139], v[64:79]
    ds_read_b64_tr_b16 v[156:157], v187 offset:6144
    buffer_load_dwordx4 v207, s[60:63], s93 offen offset:1024 lds
    v_mfma_f32_32x32x16_bf16 v[80:95], a[204:207], v[136:139], v[80:95]
    ds_read_b64_tr_b16 v[158:159], v187 offset:6656
    s_add_u32 m0, s98, 8192
    s_lshl3_add_u32 s92, s33, s99
    buffer_load_dwordx4 v224, s[72:75], s92 offen offset:0 lds
    v_dot2c_f32_bf16 v220, s95, v128
    v_dot2c_f32_bf16 v221, s95, v132
    v_dot2c_f32_bf16 v220, s95, v129
    v_dot2c_f32_bf16 v221, s95, v133
    v_dot2c_f32_bf16 v220, s95, v130
    v_dot2c_f32_bf16 v221, s95, v134
    v_dot2c_f32_bf16 v220, s95, v131
    v_dot2c_f32_bf16 v221, s95, v135
    s_waitcnt lgkmcnt(5)
    v_dot2c_f32_bf16 v220, s95, v144
    v_dot2c_f32_bf16 v221, s95, v148
    v_dot2c_f32_bf16 v220, s95, v145
    v_dot2c_f32_bf16 v221, s95, v149
    v_dot2c_f32_bf16 v220, s95, v146
    v_dot2c_f32_bf16 v221, s95, v150
    v_dot2c_f32_bf16 v220, s95, v147
    v_dot2c_f32_bf16 v221, s95, v151
    buffer_load_dwordx4 v225, s[72:75], s92 offen offset:1024 lds
    s_waitcnt lgkmcnt(0) vmcnt(13)
    s_barrier
    v_mfma_f32_32x32x16_bf16 v[96:111], v[148:151], a[208:211], v[96:111]
    ds_read_b128 v[128:131], v180 offset:32768
    ds_read_b128 a[224:227], v176 offset:32768
    s_add_u32 m0, s98, 10240
    s_xor_b32 s92, s33, 2048
    s_lshl3_add_u32 s92, s92, s99
    buffer_load_dwordx4 v224, s[72:75], s92 offen offset:0 lds
    v_mfma_f32_32x32x16_bf16 v[112:127], v[148:151], a[212:215], v[112:127]
    ds_read_b128 a[228:231], v176 offset:40960
    v_mfma_f32_32x32x16_bf16 v[64:79], a[208:211], v[144:147], v[64:79]
    ds_read_b64_tr_b16 v[132:133], v184 offset:38912
    buffer_load_dwordx4 v225, s[72:75], s92 offen offset:1024 lds
    s_movk_i32 s35, 0
    buffer_load_dwordx2 v[2:3], v18, s[48:51], s35 offen
    v_mfma_f32_32x32x16_bf16 v[80:95], a[212:215], v[144:147], v[80:95]
    ds_read_b64_tr_b16 v[134:135], v184 offset:39424
    v_mfma_f32_32x32x16_bf16 v[96:111], v[156:159], a[216:219], v[96:111]
    ds_read_b128 v[136:139], v181 offset:32768
    ds_read_b128 a[232:235], v177 offset:32768
    s_add_u32 m0, s98, 12288
    s_xor_b32 s92, s33, 4096
    s_lshl3_add_u32 s92, s92, s99
    buffer_load_dwordx4 v224, s[72:75], s92 offen offset:0 lds
    v_mfma_f32_32x32x16_bf16 v[112:127], v[156:159], a[220:223], v[112:127]
    ds_read_b128 a[236:239], v177 offset:40960
    s_waitcnt vmcnt(16)
    v_cmp_ne_u32 vcc, s96, v42
    s_cmp_lg_u64 vcc, 0
    s_cbranch_scc1 L_ga_slow
L_ga_ok:
    ds_bpermute_b32 v44, v218, v40
    v_mfma_f32_32x32x16_bf16 v[64:79], a[216:219], v[152:155], v[64:79]
    ds_read_b64_tr_b16 v[140:141], v185 offset:38912
    buffer_load_dwordx4 v225, s[72:75], s92 offen offset:1024 lds
    v_mov_b32 v200, v41
    v_mov_b32 v202, v41
    v_mov_b32 v42, v40
    v_mfma_f32_32x32x16_bf16 v[80:95], a[220:223], v[152:155], v[80:95]
    ds_read_b64_tr_b16 v[142:143], v185 offset:39424
    v_mov_b32 v43, v40
    s_lshl_b32 s13, s8, 14
    s_add_u32 s13, s13, 1048576
    v_permlane32_swap_b32 v200, v202
    s_getpc_b64 s[46:47]
L_ct1:
    s_lshr_b32 s97, s2, 3
    s_lshl2_add_u32 s97, s97, s4
    s_lshl_b32 s97, s97, 7
    s_min_u32 s97, s97, L_fin-L_ct1-4
    v_mov_b32 v240, s97
    global_load_dword v219, v240, s[46:47]
    s_waitcnt lgkmcnt(6)
    v_mfma_f32_32x32x16_bf16 v[96:111], v[132:135], a[224:227], v[96:111]
    ds_read_b128 v[144:147], v182 offset:32768
    ds_read_b128 a[240:243], v178 offset:32768
    s_add_u32 m0, s98, 14336
    s_xor_b32 s92, s33, 6144
    s_lshl3_add_u32 s92, s92, s99
    buffer_load_dwordx4 v224, s[72:75], s92 offen offset:0 lds
    v_mfma_f32_32x32x16_bf16 v[112:127], v[132:135], a[228:231], v[112:127]
    ds_read_b128 a[244:247], v178 offset:40960
    v_permlane32_swap_b32 v42, v43
    v_mov_b32 v201, v200
    v_mov_b32 v203, v202
    v_mfma_f32_32x32x16_bf16 v[64:79], a[224:227], v[128:131], v[64:79]
    ds_read_b64_tr_b16 v[148:149], v186 offset:38912
    buffer_load_dwordx4 v225, s[72:75], s92 offen offset:1024 lds
    s_add_u32 s52, s88, s13
    s_addc_u32 s53, s89, 0
    s_movk_i32 s54, 16384
    v_mfma_f32_32x32x16_bf16 v[80:95], a[228:231], v[128:131], v[80:95]
    ds_read_b64_tr_b16 v[150:151], v186 offset:39424
    s_movk_i32 s35, 4096
    buffer_load_dwordx2 v[6:7], v18, s[48:51], s35 offen
    s_waitcnt lgkmcnt(5)
    v_mfma_f32_32x32x16_bf16 v[96:111], v[140:143], a[232:235], v[96:111]
    ds_read_b128 v[152:155], v183 offset:32768
    ds_read_b128 a[248:251], v179 offset:32768
    v_mfma_f32_32x32x16_bf16 v[112:127], v[140:143], a[236:239], v[112:127]
    ds_read_b128 a[252:255], v179 offset:40960
    s_movk_i32 s35, 8192
    buffer_load_dwordx2 v[10:11], v18, s[48:51], s35 offen
    v_mfma_f32_32x32x16_bf16 v[64:79], a[232:235], v[136:139], v[64:79]
    ds_read_b64_tr_b16 v[156:157], v187 offset:38912
    v_mfma_f32_32x32x16_bf16 v[80:95], a[236:239], v[136:139], v[80:95]
    ds_read_b64_tr_b16 v[158:159], v187 offset:39424
    s_movk_i32 s35, 12288
    buffer_load_dwordx2 v[14:15], v18, s[48:51], s35 offen
    v_dot2c_f32_bf16 v220, s95, v128
    v_dot2c_f32_bf16 v221, s95, v132
    v_dot2c_f32_bf16 v220, s95, v129
    v_dot2c_f32_bf16 v221, s95, v133
    v_dot2c_f32_bf16 v220, s95, v130
    v_dot2c_f32_bf16 v221, s95, v134
    v_dot2c_f32_bf16 v220, s95, v131
    v_dot2c_f32_bf16 v221, s95, v135
    s_waitcnt lgkmcnt(5)
    v_dot2c_f32_bf16 v220, s95, v144
    v_dot2c_f32_bf16 v221, s95, v148
    v_dot2c_f32_bf16 v220, s95, v145
    v_dot2c_f32_bf16 v221, s95, v149
    v_dot2c_f32_bf16 v220, s95, v146
    v_dot2c_f32_bf16 v221, s95, v150
    v_dot2c_f32_bf16 v220, s95, v147
    v_dot2c_f32_bf16 v221, s95, v151
    s_nop 2
    ds_write_b64 v212, v[220:221]
    s_waitcnt lgkmcnt(0)
    s_barrier
    ds_read_b64 v[62:63], v213
    v_mfma_f32_32x32x16_bf16 v[96:111], v[148:151], a[240:243], v[96:111]
    v_mfma_f32_32x32x16_bf16 v[112:127], v[148:151], a[244:247], v[112:127]
    buffer_load_dwordx2 v[34:35], v34, s[88:91], 0 offen sc1
    v_mfma_f32_32x32x16_bf16 v[64:79], a[240:243], v[144:147], v[64:79]
    s_mov_b32 s95, 0x07060302
    s_waitcnt lgkmcnt(0)
    v_add_f32 v221, v221, v63
    v_add_f32 v220, v220, v62
    v_mfma_f32_32x32x16_bf16 v[80:95], a[244:247], v[144:147], v[80:95]
    v_and_b32 v240, 0xffff0000, v221
    v_sub_f32 v240, v221, v240
    v_perm_b32 v222, v240, v221, s95
    v_and_b32 v241, 0xffff0000, v240
    v_sub_f32 v241, v240, v241
    v_cvt_pk_bf16_f32 v223, v241, 0
    v_mfma_f32_32x32x16_bf16 v[96:111], v[156:159], a[248:251], v[96:111]
    v_and_b32 v240, 0xffff0000, v220
    v_sub_f32 v240, v220, v240
    v_perm_b32 v204, v240, v220, s95
    v_and_b32 v241, 0xffff0000, v240
    v_sub_f32 v241, v240, v241
    v_cvt_pk_bf16_f32 v205, v241, 0
    v_mfma_f32_32x32x16_bf16 v[112:127], v[156:159], a[252:255], v[112:127]
    v_mfma_f32_32x32x8_bf16 v[96:111], v[222:223], v[200:201], v[96:111]
    v_mfma_f32_32x32x8_bf16 v[112:127], v[222:223], v[202:203], v[112:127]
    v_mfma_f32_32x32x16_bf16 v[64:79], a[248:251], v[152:155], v[64:79]
    v_mfma_f32_32x32x16_bf16 v[80:95], a[252:255], v[152:155], v[80:95]
    v_mfma_f32_32x32x8_bf16 v[64:79], v[200:201], v[204:205], v[64:79]
    v_mfma_f32_32x32x8_bf16 v[80:95], v[202:203], v[204:205], v[80:95]
    v_mov_b32 v220, s96
    s_nop 5
    v_pk_mul_f32 v[96:97], v[96:97], v[42:43] op_sel:[0,0] op_sel_hi:[1,0]
    v_pk_mul_f32 v[98:99], v[98:99], v[42:43] op_sel:[0,0] op_sel_hi:[1,0]
    v_pk_mul_f32 v[100:101], v[100:101], v[42:43] op_sel:[0,0] op_sel_hi:[1,0]
    v_pk_mul_f32 v[102:103], v[102:103], v[42:43] op_sel:[0,0] op_sel_hi:[1,0]
    v_pk_mul_f32 v[104:105], v[104:105], v[42:43] op_sel:[0,0] op_sel_hi:[1,0]
    v_pk_mul_f32 v[106:107], v[106:107], v[42:43] op_sel:[0,0] op_sel_hi:[1,0]
    v_pk_mul_f32 v[108:109], v[108:109], v[42:43] op_sel:[0,0] op_sel_hi:[1,0]
    v_pk_mul_f32 v[110:111], v[110:111], v[42:43] op_sel:[0,0] op_sel_hi:[1,0]
    v_cvt_pk_bf16_f32 v96, v96, v97
    s_add_u32 m0, s94, 0
    s_bfe_u32 s93, s11, 196624
    s_mul_i32 s93, s93, 229376
    buffer_load_dwordx4 v206, s[60:63], s93 offen offset:0 lds
    v_cvt_pk_bf16_f32 v97, v98, v99
    v_cvt_pk_bf16_f32 v98, v100, v101
    v_cvt_pk_bf16_f32 v99, v102, v103
    v_cvt_pk_bf16_f32 v100, v104, v105
    v_cvt_pk_bf16_f32 v101, v106, v107
    v_cvt_pk_bf16_f32 v102, v108, v109
    v_cvt_pk_bf16_f32 v103, v110, v111
    v_pk_max_i16 v96, v96, 0
    v_pk_max_i16 v97, v97, 0
    v_pk_max_i16 v98, v98, 0
    buffer_load_dwordx4 v207, s[60:63], s93 offen offset:1024 lds
    v_pk_max_i16 v99, v99, 0
    v_pk_max_i16 v100, v100, 0
    v_pk_max_i16 v101, v101, 0
    v_pk_max_i16 v102, v102, 0
    v_pk_max_i16 v103, v103, 0
    v_pk_mul_f32 v[112:113], v[112:113], v[42:43] op_sel:[0,1] op_sel_hi:[1,1]
    v_pk_mul_f32 v[114:115], v[114:115], v[42:43] op_sel:[0,1] op_sel_hi:[1,1]
    v_pk_mul_f32 v[116:117], v[116:117], v[42:43] op_sel:[0,1] op_sel_hi:[1,1]
    v_pk_mul_f32 v[118:119], v[118:119], v[42:43] op_sel:[0,1] op_sel_hi:[1,1]
    s_add_u32 m0, s94, 2048
    s_bfe_u32 s93, s11, 196628
    s_mul_i32 s93, s93, 229376
    buffer_load_dwordx4 v206, s[60:63], s93 offen offset:0 lds
    v_pk_mul_f32 v[120:121], v[120:121], v[42:43] op_sel:[0,1] op_sel_hi:[1,1]
    v_pk_mul_f32 v[122:123], v[122:123], v[42:43] op_sel:[0,1] op_sel_hi:[1,1]
    v_pk_mul_f32 v[124:125], v[124:125], v[42:43] op_sel:[0,1] op_sel_hi:[1,1]
    v_pk_mul_f32 v[126:127], v[126:127], v[42:43] op_sel:[0,1] op_sel_hi:[1,1]
    v_cvt_pk_bf16_f32 v112, v112, v113
    v_cvt_pk_bf16_f32 v113, v114, v115
    v_cvt_pk_bf16_f32 v114, v116, v117
    v_cvt_pk_bf16_f32 v115, v118, v119
    v_cvt_pk_bf16_f32 v116, v120, v121
    v_cvt_pk_bf16_f32 v117, v122, v123
    buffer_load_dwordx4 v207, s[60:63], s93 offen offset:1024 lds
    v_cvt_pk_bf16_f32 v118, v124, v125
    v_cvt_pk_bf16_f32 v119, v126, v127
    v_pk_max_i16 v112, v112, 0
    v_pk_max_i16 v113, v113, 0
    v_pk_max_i16 v114, v114, 0
    v_pk_max_i16 v115, v115, 0
    v_pk_max_i16 v116, v116, 0
    v_pk_max_i16 v117, v117, 0
    v_pk_max_i16 v118, v118, 0
    v_pk_max_i16 v119, v119, 0
    v_permlane16_swap_b32 v64, v80
    v_permlane16_swap_b32 v65, v81
    v_permlane16_swap_b32 v66, v82
    v_permlane16_swap_b32 v67, v83
    v_permlane16_swap_b32 v68, v84
    v_permlane16_swap_b32 v69, v85
    v_permlane16_swap_b32 v70, v86
    v_permlane16_swap_b32 v71, v87
    v_permlane16_swap_b32 v72, v88
    v_permlane16_swap_b32 v73, v89
    buffer_store_dwordx2 v[220:221], v209, s[88:91], 0 offen sc1
    v_permlane16_swap_b32 v74, v90
    v_permlane16_swap_b32 v75, v91
    v_permlane16_swap_b32 v76, v92
    v_permlane16_swap_b32 v77, v93
    v_permlane16_swap_b32 v78, v94
    v_permlane16_swap_b32 v79, v95
    v_mul_f32_dpp v64, v44, v64 row_newbcast:0 row_mask:0xf bank_mask:0xf
    v_mul_f32_dpp v80, v44, v80 row_newbcast:0 row_mask:0xf bank_mask:0xf
    v_mul_f32_dpp v65, v44, v65 row_newbcast:1 row_mask:0xf bank_mask:0xf
    v_mul_f32_dpp v81, v44, v81 row_newbcast:1 row_mask:0xf bank_mask:0xf
    v_fma_f32 v48, v20, v64, v65
    buffer_store_dwordx4 v[96:99], v216, s[88:91], 0 offen offset:0 sc1
    v_fma_f32 v49, v20, v80, v81
    v_mul_f32_dpp v66, v44, v66 row_newbcast:2 row_mask:0xf bank_mask:0xf
    v_mul_f32_dpp v82, v44, v82 row_newbcast:2 row_mask:0xf bank_mask:0xf
    v_fma_f32 v48, -v21, v80, v48
    v_fma_f32 v49, v21, v64, v49
    v_fma_f32 v46, v20, v48, v66
    v_fma_f32 v47, v20, v49, v82
    v_mul_f32_dpp v67, v44, v67 row_newbcast:3 row_mask:0xf bank_mask:0xf
    v_mul_f32_dpp v83, v44, v83 row_newbcast:3 row_mask:0xf bank_mask:0xf
    v_fma_f32 v46, -v21, v49, v46
    v_fma_f32 v47, v21, v48, v47
    buffer_store_dwordx4 v[100:103], v216, s[88:91], 0 offen offset:2048 sc1
    v_fma_f32 v48, v20, v46, v67
    v_fma_f32 v49, v20, v47, v83
    v_mul_f32_dpp v68, v44, v68 row_newbcast:4 row_mask:0xf bank_mask:0xf
    v_mul_f32_dpp v84, v44, v84 row_newbcast:4 row_mask:0xf bank_mask:0xf
    v_fma_f32 v48, -v21, v47, v48
    v_fma_f32 v49, v21, v46, v49
    v_fma_f32 v46, v20, v48, v68
    v_fma_f32 v47, v20, v49, v84
    v_mul_f32_dpp v69, v44, v69 row_newbcast:5 row_mask:0xf bank_mask:0xf
    v_mul_f32_dpp v85, v44, v85 row_newbcast:5 row_mask:0xf bank_mask:0xf
    v_fma_f32 v46, -v21, v49, v46
    buffer_store_dwordx4 v[112:115], v216, s[88:91], 0 offen offset:1024 sc1
    v_fma_f32 v47, v21, v48, v47
    v_fma_f32 v48, v20, v46, v69
    v_fma_f32 v49, v20, v47, v85
    v_mul_f32_dpp v70, v44, v70 row_newbcast:6 row_mask:0xf bank_mask:0xf
    v_mul_f32_dpp v86, v44, v86 row_newbcast:6 row_mask:0xf bank_mask:0xf
    v_fma_f32 v48, -v21, v47, v48
    v_fma_f32 v49, v21, v46, v49
    v_fma_f32 v46, v20, v48, v70
    v_fma_f32 v47, v20, v49, v86
    v_mul_f32_dpp v71, v44, v71 row_newbcast:7 row_mask:0xf bank_mask:0xf
    v_mul_f32_dpp v87, v44, v87 row_newbcast:7 row_mask:0xf bank_mask:0xf
    buffer_store_dwordx4 v[116:119], v216, s[88:91], 0 offen offset:3072 sc1
    v_fma_f32 v46, -v21, v49, v46
    v_fma_f32 v47, v21, v48, v47
    v_fma_f32 v48, v20, v46, v71
    v_fma_f32 v49, v20, v47, v87
    v_mul_f32_dpp v72, v44, v72 row_newbcast:8 row_mask:0xf bank_mask:0xf
    v_mul_f32_dpp v88, v44, v88 row_newbcast:8 row_mask:0xf bank_mask:0xf
    v_fma_f32 v48, -v21, v47, v48
    v_fma_f32 v49, v21, v46, v49
    v_fma_f32 v46, v20, v48, v72
    v_fma_f32 v47, v20, v49, v88
    s_add_u32 m0, s94, 4096
    s_bfe_u32 s93, s11, 196632
    s_mul_i32 s93, s93, 229376
    buffer_load_dwordx4 v206, s[60:63], s93 offen offset:0 lds
    v_mul_f32_dpp v73, v44, v73 row_newbcast:9 row_mask:0xf bank_mask:0xf
    v_mul_f32_dpp v89, v44, v89 row_newbcast:9 row_mask:0xf bank_mask:0xf
    v_fma_f32 v46, -v21, v49, v46
    v_fma_f32 v47, v21, v48, v47
    v_fma_f32 v48, v20, v46, v73
    v_fma_f32 v49, v20, v47, v89
    v_mul_f32_dpp v74, v44, v74 row_newbcast:10 row_mask:0xf bank_mask:0xf
    v_mul_f32_dpp v90, v44, v90 row_newbcast:10 row_mask:0xf bank_mask:0xf
    v_fma_f32 v48, -v21, v47, v48
    v_fma_f32 v49, v21, v46, v49
    v_fma_f32 v46, v20, v48, v74
    buffer_load_dwordx4 v207, s[60:63], s93 offen offset:1024 lds
    v_fma_f32 v47, v20, v49, v90
    v_mul_f32_dpp v75, v44, v75 row_newbcast:11 row_mask:0xf bank_mask:0xf
    v_mul_f32_dpp v91, v44, v91 row_newbcast:11 row_mask:0xf bank_mask:0xf
    v_fma_f32 v46, -v21, v49, v46
    v_fma_f32 v47, v21, v48, v47
    v_fma_f32 v48, v20, v46, v75
    v_fma_f32 v49, v20, v47, v91
    v_mul_f32_dpp v76, v44, v76 row_newbcast:12 row_mask:0xf bank_mask:0xf
    v_mul_f32_dpp v92, v44, v92 row_newbcast:12 row_mask:0xf bank_mask:0xf
    v_fma_f32 v48, -v21, v47, v48
    v_fma_f32 v49, v21, v46, v49
    s_add_u32 m0, s94, 6144
    s_bfe_u32 s93, s11, 196636
    s_mul_i32 s93, s93, 229376
    buffer_load_dwordx4 v206, s[60:63], s93 offen offset:0 lds
    v_fma_f32 v46, v20, v48, v76
    v_fma_f32 v47, v20, v49, v92
    v_mul_f32_dpp v77, v44, v77 row_newbcast:13 row_mask:0xf bank_mask:0xf
    v_mul_f32_dpp v93, v44, v93 row_newbcast:13 row_mask:0xf bank_mask:0xf
    v_fma_f32 v46, -v21, v49, v46
    v_fma_f32 v47, v21, v48, v47
    v_fma_f32 v48, v20, v46, v77
    v_fma_f32 v49, v20, v47, v93
    v_mul_f32_dpp v78, v44, v78 row_newbcast:14 row_mask:0xf bank_mask:0xf
    v_mul_f32_dpp v94, v44, v94 row_newbcast:14 row_mask:0xf bank_mask:0xf
    v_fma_f32 v48, -v21, v47, v48
    buffer_load_dwordx4 v207, s[60:63], s93 offen offset:1024 lds
    v_fma_f32 v49, v21, v46, v49
    v_fma_f32 v46, v20, v48, v78
    v_fma_f32 v47, v20, v49, v94
    v_mul_f32_dpp v79, v44, v79 row_newbcast:15 row_mask:0xf bank_mask:0xf
    v_mul_f32_dpp v95, v44, v95 row_newbcast:15 row_mask:0xf bank_mask:0xf
    v_fma_f32 v46, -v21, v49, v46
    v_fma_f32 v47, v21, v48, v47
    v_fma_f32 v48, v20, v46, v79
    v_fma_f32 v49, v20, v47, v95
    v_fma_f32 v48, -v21, v47, v48
    v_fma_f32 v49, v21, v46, v49
    v_mov_b32 v50, v48
    v_mov_b32 v51, v49
    v_mov_b32 v62, s96
    v_mov_b32 v40, 0
    v_permlane32_swap_b32 v48, v50
    v_permlane32_swap_b32 v49, v51
    v_mov_b32 v52, v48
    v_mov_b32 v54, v50
    v_mov_b32 v53, v49
    v_mov_b32 v55, v51
    v_permlane16_swap_b32 v48, v52
    v_permlane16_swap_b32 v50, v54
    v_permlane16_swap_b32 v49, v53
    v_permlane16_swap_b32 v51, v55
    v_mov_b32 v41, 0
    v_fma_f32 v50, v22, v48, v50
    v_fma_f32 v51, v22, v49, v51
    v_fma_f32 v50, -v23, v49, v50
    v_fma_f32 v51, v23, v48, v51
    v_fma_f32 v52, v22, v50, v52
    v_fma_f32 v53, v22, v51, v53
    v_fma_f32 v52, -v23, v51, v52
    v_fma_f32 v53, v23, v50, v53
    v_fma_f32 v60, v22, v52, v54
    v_fma_f32 v61, v22, v53, v55
    v_fma_f32 v60, -v23, v53, v60
    v_fma_f32 v61, v23, v52, v61
    buffer_store_dwordx4 v[60:63], v215, s[88:91], 0 offen sc1
    s_waitcnt vmcnt(28)
    s_barrier
    ds_read_b64_tr_b16 v[160:161], v196 offset:0
    ds_read_b64_tr_b16 v[162:163], v196 offset:512
    ds_read_b64_tr_b16 v[164:165], v197 offset:0
    ds_read_b64_tr_b16 v[166:167], v197 offset:512
    ds_read_b64_tr_b16 v[168:169], v198 offset:0
    ds_read_b64_tr_b16 v[170:171], v198 offset:512
    v_cmp_eq_u32 vcc, 1, v32
    s_nop 1
    v_cndmask_b32 v40, v40, v48, vcc
    v_cndmask_b32 v41, v41, v49, vcc
    v_cmp_eq_u32 vcc, 2, v32
    s_nop 1
    v_cndmask_b32 v40, v40, v50, vcc
    v_cndmask_b32 v41, v41, v51, vcc
    v_cmp_eq_u32 vcc, 3, v32
    s_nop 1
    v_cndmask_b32 v40, v40, v52, vcc
    v_cndmask_b32 v41, v41, v53, vcc
    s_waitcnt lgkmcnt(4)
    v_mfma_f32_32x32x16_bf16 v[128:143], v[160:163], a[0:3], 0
    ds_read_b64_tr_b16 v[172:173], v199 offset:0
    s_add_u32 m0, s94, 32768
    s_lshl3_add_u32 s92, s100, s99
    buffer_load_dwordx4 v224, s[72:75], s92 offen offset:0 lds
    v_mul_f32 v46, v31, v80
    v_mfma_f32_32x32x16_bf16 v[144:159], v[160:163], a[4:7], 0
    ds_read_b64_tr_b16 v[174:175], v199 offset:512
    v_mul_f32 v80, v30, v80
    v_fmac_f32 v80, v31, v64
    v_fma_f32 v64, v30, v64, -v46
    v_mul_f32 v46, v31, v81
    s_waitcnt lgkmcnt(4)
    v_mfma_f32_32x32x16_bf16 v[128:143], v[164:167], a[8:11], v[128:143]
    ds_read_b64_tr_b16 v[160:161], v196 offset:2048
    buffer_load_dwordx4 v225, s[72:75], s92 offen offset:1024 lds
    v_mul_f32 v81, v30, v81
    v_fmac_f32 v81, v31, v65
    v_fma_f32 v65, v30, v65, -v46
    v_mfma_f32_32x32x16_bf16 v[144:159], v[164:167], a[12:15], v[144:159]
    ds_read_b64_tr_b16 v[162:163], v196 offset:2560
    v_mul_f32 v46, v31, v82
    v_mul_f32 v82, v30, v82
    v_fmac_f32 v82, v31, v66
    v_fma_f32 v66, v30, v66, -v46
    s_waitcnt lgkmcnt(4)
    v_mfma_f32_32x32x16_bf16 v[128:143], v[168:171], a[16:19], v[128:143]
    ds_read_b64_tr_b16 v[164:165], v197 offset:2048
    s_add_u32 m0, s94, 34816
    s_xor_b32 s92, s100, 2048
    s_lshl3_add_u32 s92, s92, s99
    buffer_load_dwordx4 v224, s[72:75], s92 offen offset:0 lds
    v_mfma_f32_32x32x16_bf16 v[144:159], v[168:171], a[20:23], v[144:159]
    ds_read_b64_tr_b16 v[166:167], v197 offset:2560
    v_mul_f32 v46, v31, v83
    v_mul_f32 v83, v30, v83
    v_fmac_f32 v83, v31, v67
    v_fma_f32 v67, v30, v67, -v46
    s_waitcnt lgkmcnt(4)
    v_mfma_f32_32x32x16_bf16 v[128:143], v[172:175], a[24:27], v[128:143]
    ds_read_b64_tr_b16 v[168:169], v198 offset:2048
    buffer_load_dwordx4 v225, s[72:75], s92 offen offset:1024 lds
    v_mul_f32 v46, v31, v84
    v_mul_f32 v84, v30, v84
    v_fmac_f32 v84, v31, v68
    v_mfma_f32_32x32x16_bf16 v[144:159], v[172:175], a[28:31], v[144:159]
    ds_read_b64_tr_b16 v[170:171], v198 offset:2560
    v_fma_f32 v68, v30, v68, -v46
    v_mul_f32 v46, v31, v85
    v_mul_f32 v85, v30, v85
    v_fmac_f32 v85, v31, v69
    s_waitcnt lgkmcnt(4)
    v_mfma_f32_32x32x16_bf16 v[128:143], v[160:163], a[32:35], v[128:143]
    ds_read_b64_tr_b16 v[172:173], v199 offset:2048
    s_add_u32 m0, s94, 36864
    s_xor_b32 s92, s100, 4096
    s_lshl3_add_u32 s92, s92, s99
    buffer_load_dwordx4 v224, s[72:75], s92 offen offset:0 lds
    v_mfma_f32_32x32x16_bf16 v[144:159], v[160:163], a[36:39], v[144:159]
    ds_read_b64_tr_b16 v[174:175], v199 offset:2560
    v_fma_f32 v69, v30, v69, -v46
    v_mul_f32 v46, v31, v86
    v_mul_f32 v86, v30, v86
    v_fmac_f32 v86, v31, v70
    s_waitcnt lgkmcnt(4)
    v_mfma_f32_32x32x16_bf16 v[128:143], v[164:167], a[40:43], v[128:143]
    ds_read_b64_tr_b16 v[160:161], v196 offset:4096
    buffer_load_dwordx4 v225, s[72:75], s92 offen offset:1024 lds
    v_add_u32 v234, s98, v232
    v_xor_b32 v235, 64, v234
    v_fma_f32 v70, v30, v70, -v46
    v_mfma_f32_32x32x16_bf16 v[144:159], v[164:167], a[44:47], v[144:159]
    ds_read_b64_tr_b16 v[162:163], v196 offset:4608
    ds_read_b64_tr_b16 a[0:1], v234 offset:0
    ds_read_b64_tr_b16 a[2:3], v234 offset:1024
    ds_read_b64_tr_b16 a[4:5], v235 offset:0
    s_waitcnt lgkmcnt(7)
    v_mfma_f32_32x32x16_bf16 v[128:143], v[168:171], a[48:51], v[128:143]
    ds_read_b64_tr_b16 v[164:165], v197 offset:4096
    s_add_u32 m0, s94, 38912
    s_xor_b32 s92, s100, 6144
    s_lshl3_add_u32 s92, s92, s99
    buffer_load_dwordx4 v224, s[72:75], s92 offen offset:0 lds
    v_mfma_f32_32x32x16_bf16 v[144:159], v[168:171], a[52:55], v[144:159]
    ds_read_b64_tr_b16 v[166:167], v197 offset:4608
    ds_read_b64_tr_b16 a[6:7], v235 offset:1024
    ds_read_b64_tr_b16 a[8:9], v234 offset:2048
    ds_read_b64_tr_b16 a[10:11], v234 offset:3072
    ds_read_b64_tr_b16 a[12:13], v235 offset:2048
    s_waitcnt lgkmcnt(11)
    v_mfma_f32_32x32x16_bf16 v[128:143], v[172:175], a[56:59], v[128:143]
    ds_read_b64_tr_b16 v[168:169], v198 offset:4096
    buffer_load_dwordx4 v225, s[72:75], s92 offen offset:1024 lds
    ds_read_b64_tr_b16 a[14:15], v235 offset:3072
    ds_read_b64_tr_b16 a[16:17], v234 offset:4096
    ds_read_b64_tr_b16 a[18:19], v234 offset:5120
    v_mfma_f32_32x32x16_bf16 v[144:159], v[172:175], a[60:63], v[144:159]
    ds_read_b64_tr_b16 v[170:171], v198 offset:4608
    ds_read_b64_tr_b16 a[20:21], v235 offset:4096
    ds_read_b64_tr_b16 a[22:23], v235 offset:5120
    ds_read_b64_tr_b16 a[24:25], v234 offset:6144
    ds_read_b64_tr_b16 a[26:27], v234 offset:7168
    s_waitcnt lgkmcnt(15)
    v_mfma_f32_32x32x16_bf16 v[128:143], v[160:163], a[64:67], v[128:143]
    ds_read_b64_tr_b16 v[172:173], v199 offset:4096
    ds_read_b64_tr_b16 a[28:29], v235 offset:6144
    ds_read_b64_tr_b16 a[30:31], v235 offset:7168
    v_mul_f32 v46, v31, v87
    v_mul_f32 v87, v30, v87
    v_mfma_f32_32x32x16_bf16 v[144:159], v[160:163], a[68:71], v[144:159]
    ds_read_b64_tr_b16 v[174:175], v199 offset:4608
    v_fmac_f32 v87, v31, v71
    v_fma_f32 v71, v30, v71, -v46
    v_mul_f32 v46, v31, v88
    v_mul_f32 v88, v30, v88
    s_waitcnt lgkmcnt(15)
    v_mfma_f32_32x32x16_bf16 v[128:143], v[164:167], a[72:75], v[128:143]
    ds_read_b64_tr_b16 v[160:161], v196 offset:6144
    v_add_u32 v234, s98, v232
    v_xor_b32 v235, 64, v234
    s_waitcnt vmcnt(26)
    ds_read_b64_tr_b16 a[32:33], v234 offset:8192
    v_mfma_f32_32x32x16_bf16 v[144:159], v[164:167], a[76:79], v[144:159]
    ds_read_b64_tr_b16 v[162:163], v196 offset:6656
    ds_read_b64_tr_b16 a[34:35], v234 offset:9216
    ds_read_b64_tr_b16 a[36:37], v235 offset:8192
    ds_read_b64_tr_b16 a[38:39], v235 offset:9216
    ds_read_b64_tr_b16 a[40:41], v234 offset:10240
    s_waitcnt lgkmcnt(15)
    v_mfma_f32_32x32x16_bf16 v[128:143], v[168:171], a[80:83], v[128:143]
    ds_read_b64_tr_b16 v[164:165], v197 offset:6144
    ds_read_b64_tr_b16 a[42:43], v234 offset:11264
    ds_read_b64_tr_b16 a[44:45], v235 offset:10240
    ds_read_b64_tr_b16 a[46:47], v235 offset:11264
    ds_read_b64_tr_b16 a[48:49], v234 offset:12288
    v_mfma_f32_32x32x16_bf16 v[144:159], v[168:171], a[84:87], v[144:159]
    ds_read_b64_tr_b16 v[166:167], v197 offset:6656
    ds_read_b64_tr_b16 a[50:51], v234 offset:13312
    ds_read_b64_tr_b16 a[52:53], v235 offset:12288
    ds_read_b64_tr_b16 a[54:55], v235 offset:13312
    ds_read_b64_tr_b16 a[56:57], v234 offset:14336
    s_waitcnt lgkmcnt(15)
    v_mfma_f32_32x32x16_bf16 v[128:143], v[172:175], a[88:91], v[128:143]
    ds_read_b64_tr_b16 v[168:169], v198 offset:6144
    ds_read_b64_tr_b16 a[58:59], v234 offset:15360
    ds_read_b64_tr_b16 a[60:61], v235 offset:14336
    ds_read_b64_tr_b16 a[62:63], v235 offset:15360
    v_fmac_f32 v88, v31, v72
    v_mfma_f32_32x32x16_bf16 v[144:159], v[172:175], a[92:95], v[144:159]
    ds_read_b64_tr_b16 v[170:171], v198 offset:6656
    v_fma_f32 v72, v30, v72, -v46
    v_mul_f32 v46, v31, v89
    v_mul_f32 v89, v30, v89
    v_fmac_f32 v89, v31, v73
    s_waitcnt lgkmcnt(15)
    v_mfma_f32_32x32x16_bf16 v[128:143], v[160:163], a[96:99], v[128:143]
    ds_read_b64_tr_b16 v[172:173], v199 offset:6144
    buffer_load_dwordx2 v[220:221], v211, s[88:91], 0 offen sc1
    s_waitcnt vmcnt(14)
    buffer_store_dword v251, v243, s[88:91], 0 offen offset:0 sc1
    v_fma_f32 v73, v30, v73, -v46
    v_mfma_f32_32x32x16_bf16 v[144:159], v[160:163], a[100:103], v[144:159]
    ds_read_b64_tr_b16 v[174:175], v199 offset:6656
    v_mul_f32 v46, v31, v90
    v_mul_f32 v90, v30, v90
    v_fmac_f32 v90, v31, v74
    v_fma_f32 v74, v30, v74, -v46
    s_waitcnt lgkmcnt(0) vmcnt(11)
    s_barrier
    v_mfma_f32_32x32x16_bf16 v[128:143], v[164:167], a[104:107], v[128:143]
    ds_read_b64_tr_b16 v[160:161], v184 offset:0
    s_add_u32 m0, s98, 0
    s_add_u32 s92, s3, 0
    buffer_load_dwordx4 v228, s[76:79], s92 offen offset:0 lds
    v_mfma_f32_32x32x16_bf16 v[144:159], v[164:167], a[108:111], v[144:159]
    ds_read_b64_tr_b16 v[162:163], v184 offset:512
    v_mul_f32 v46, v31, v91
    v_mul_f32 v91, v30, v91
    v_fmac_f32 v91, v31, v75
    v_fma_f32 v75, v30, v75, -v46
    v_mfma_f32_32x32x16_bf16 v[128:143], v[168:171], a[112:115], v[128:143]
    ds_read_b64_tr_b16 v[164:165], v185 offset:0
    buffer_load_dwordx4 v229, s[76:79], s92 offen offset:1024 lds
    v_mul_f32 v46, v31, v92
    v_mul_f32 v92, v30, v92
    v_fmac_f32 v92, v31, v76
    v_mfma_f32_32x32x16_bf16 v[144:159], v[168:171], a[116:119], v[144:159]
    ds_read_b64_tr_b16 v[166:167], v185 offset:512
    v_fma_f32 v76, v30, v76, -v46
    v_mul_f32 v46, v31, v93
    v_mul_f32 v93, v30, v93
    v_fmac_f32 v93, v31, v77
    v_mfma_f32_32x32x16_bf16 v[128:143], v[172:175], a[120:123], v[128:143]
    ds_read_b64_tr_b16 v[168:169], v186 offset:0
    buffer_load_dwordx4 v230, s[76:79], s92 offen offset:2048 lds
    v_fma_f32 v77, v30, v77, -v46
    v_mul_f32 v46, v31, v94
    v_mul_f32 v94, v30, v94
    v_mfma_f32_32x32x16_bf16 v[144:159], v[172:175], a[124:127], v[144:159]
    ds_read_b64_tr_b16 v[170:171], v186 offset:512
    v_fmac_f32 v94, v31, v78
    v_fma_f32 v78, v30, v78, -v46
    v_mul_f32 v46, v31, v95
    v_mul_f32 v95, v30, v95
    s_waitcnt lgkmcnt(4)
    v_mfma_f32_32x32x16_bf16 v[128:143], v[160:163], a[128:131], v[128:143]
    ds_read_b64_tr_b16 v[172:173], v187 offset:0
    buffer_load_dwordx4 v231, s[76:79], s92 offen offset:3072 lds
    v_fmac_f32 v95, v31, v79
    v_fma_f32 v79, v30, v79, -v46
    v_mfma_f32_32x32x16_bf16 v[144:159], v[160:163], a[132:135], v[144:159]
    ds_read_b64_tr_b16 v[174:175], v187 offset:512
    s_waitcnt lgkmcnt(4)
    v_mfma_f32_32x32x16_bf16 v[128:143], v[164:167], a[136:139], v[128:143]
    ds_read_b64_tr_b16 v[160:161], v184 offset:2048
    s_add_u32 m0, s98, 4096
    s_add_u32 s92, s3, 32768
    buffer_load_dwordx4 v228, s[76:79], s92 offen offset:0 lds
    v_mfma_f32_32x32x16_bf16 v[144:159], v[164:167], a[140:143], v[144:159]
    ds_read_b64_tr_b16 v[162:163], v184 offset:2560
    s_waitcnt lgkmcnt(4)
    v_mfma_f32_32x32x16_bf16 v[128:143], v[168:171], a[144:147], v[128:143]
    ds_read_b64_tr_b16 v[164:165], v185 offset:2048
    buffer_load_dwordx4 v229, s[76:79], s92 offen offset:1024 lds
    v_mfma_f32_32x32x16_bf16 v[144:159], v[168:171], a[148:151], v[144:159]
    ds_read_b64_tr_b16 v[166:167], v185 offset:2560
    s_waitcnt lgkmcnt(4)
    v_mfma_f32_32x32x16_bf16 v[128:143], v[172:175], a[152:155], v[128:143]
    ds_read_b64_tr_b16 v[168:169], v186 offset:2048
    buffer_load_dwordx4 v230, s[76:79], s92 offen offset:2048 lds
    v_mfma_f32_32x32x16_bf16 v[144:159], v[172:175], a[156:159], v[144:159]
    ds_read_b64_tr_b16 v[170:171], v186 offset:2560
    s_waitcnt lgkmcnt(4)
    v_mfma_f32_32x32x16_bf16 v[128:143], v[160:163], a[160:163], v[128:143]
    ds_read_b64_tr_b16 v[172:173], v187 offset:2048
    buffer_load_dwordx4 v231, s[76:79], s92 offen offset:3072 lds
    v_mfma_f32_32x32x16_bf16 v[144:159], v[160:163], a[164:167], v[144:159]
    ds_read_b64_tr_b16 v[174:175], v187 offset:2560
    s_waitcnt lgkmcnt(4)
    v_mfma_f32_32x32x16_bf16 v[128:143], v[164:167], a[168:171], v[128:143]
    ds_read_b64_tr_b16 v[160:161], v184 offset:4096
    s_add_u32 m0, s94, 65536
    s_lshl3_add_u32 s92, s101, s99
    buffer_load_dwordx4 v224, s[72:75], s92 offen offset:0 lds
    v_mfma_f32_32x32x16_bf16 v[144:159], v[164:167], a[172:175], v[144:159]
    ds_read_b64_tr_b16 v[162:163], v184 offset:4608
    s_waitcnt lgkmcnt(4)
    v_mfma_f32_32x32x16_bf16 v[128:143], v[168:171], a[176:179], v[128:143]
    ds_read_b64_tr_b16 v[164:165], v185 offset:4096
    buffer_load_dwordx4 v225, s[72:75], s92 offen offset:1024 lds
    v_mfma_f32_32x32x16_bf16 v[144:159], v[168:171], a[180:183], v[144:159]
    ds_read_b64_tr_b16 v[166:167], v185 offset:4608
    s_waitcnt lgkmcnt(4)
    v_mfma_f32_32x32x16_bf16 v[128:143], v[172:175], a[184:187], v[128:143]
    ds_read_b64_tr_b16 v[168:169], v186 offset:4096
    buffer_load_dwordx4 v226, s[72:75], s92 offen offset:2048 lds
    v_mfma_f32_32x32x16_bf16 v[144:159], v[172:175], a[188:191], v[144:159]
    ds_read_b64_tr_b16 v[170:171], v186 offset:4608
    s_waitcnt lgkmcnt(4)
    v_mfma_f32_32x32x16_bf16 v[128:143], v[160:163], a[192:195], v[128:143]
    ds_read_b64_tr_b16 v[172:173], v187 offset:4096
    buffer_load_dwordx4 v227, s[72:75], s92 offen offset:3072 lds
    v_mfma_f32_32x32x16_bf16 v[144:159], v[160:163], a[196:199], v[144:159]
    ds_read_b64_tr_b16 v[174:175], v187 offset:4608
    s_waitcnt lgkmcnt(4)
    v_mfma_f32_32x32x16_bf16 v[128:143], v[164:167], a[200:203], v[128:143]
    ds_read_b64_tr_b16 v[160:161], v184 offset:6144
    buffer_load_dwordx3 v[96:98], v238, s[52:55], 0 offen offset:0 sc1
    buffer_load_dwordx3 v[100:102], v238, s[52:55], 0 offen offset:512 sc1
    v_mfma_f32_32x32x16_bf16 v[144:159], v[164:167], a[204:207], v[144:159]
    ds_read_b64_tr_b16 v[162:163], v184 offset:6656
    s_waitcnt lgkmcnt(4)
    v_mfma_f32_32x32x16_bf16 v[128:143], v[168:171], a[208:211], v[128:143]
    ds_read_b64_tr_b16 v[164:165], v185 offset:6144
    buffer_load_dwordx3 v[104:106], v238, s[52:55], 0 offen offset:1024 sc1
    buffer_load_dwordx3 v[108:110], v238, s[52:55], 0 offen offset:1536 sc1
    v_mfma_f32_32x32x16_bf16 v[144:159], v[168:171], a[212:215], v[144:159]
    ds_read_b64_tr_b16 v[166:167], v185 offset:6656
    s_waitcnt lgkmcnt(4)
    v_mfma_f32_32x32x16_bf16 v[128:143], v[172:175], a[216:219], v[128:143]
    ds_read_b64_tr_b16 v[168:169], v186 offset:6144
    buffer_load_dwordx3 v[112:114], v238, s[52:55], 0 offen offset:2048 sc1
    buffer_load_dwordx3 v[116:118], v238, s[52:55], 0 offen offset:2560 sc1
    v_mfma_f32_32x32x16_bf16 v[144:159], v[172:175], a[220:223], v[144:159]
    ds_read_b64_tr_b16 v[170:171], v186 offset:6656
    s_waitcnt lgkmcnt(4)
    v_mfma_f32_32x32x16_bf16 v[128:143], v[160:163], a[224:227], v[128:143]
    ds_read_b64_tr_b16 v[172:173], v187 offset:6144
    buffer_load_dwordx3 v[120:122], v238, s[52:55], 0 offen offset:3072 sc1
    buffer_load_dwordx3 v[124:126], v238, s[52:55], 0 offen offset:3584 sc1
    v_mfma_f32_32x32x16_bf16 v[144:159], v[160:163], a[228:231], v[144:159]
    ds_read_b64_tr_b16 v[174:175], v187 offset:6656
    s_waitcnt lgkmcnt(4)
    v_mfma_f32_32x32x16_bf16 v[128:143], v[164:167], a[232:235], v[128:143]
    v_mfma_f32_32x32x16_bf16 v[144:159], v[164:167], a[236:239], v[144:159]
    s_waitcnt lgkmcnt(2)
    v_mfma_f32_32x32x16_bf16 v[128:143], v[168:171], a[240:243], v[128:143]
    s_waitcnt vmcnt(21)
    v_cmp_ne_u32 vcc, s96, v220
    s_cmp_lg_u64 vcc, 0
    s_cbranch_scc1 L_c2_slow
L_c2_ok:
    v_mfma_f32_32x32x16_bf16 v[144:159], v[168:171], a[244:247], v[144:159]
    v_and_b32 v240, 0xffff0000, v221
    v_sub_f32 v240, v221, v240
    v_perm_b32 v222, v240, v221, s95
    v_and_b32 v241, 0xffff0000, v240
    v_sub_f32 v241, v240, v241
    v_cvt_pk_bf16_f32 v223, v241, 0
    s_waitcnt lgkmcnt(0)
    v_mfma_f32_32x32x16_bf16 v[128:143], v[172:175], a[248:251], v[128:143]
    v_mfma_f32_32x32x16_bf16 v[144:159], v[172:175], a[252:255], v[144:159]
    v_mfma_f32_32x32x8_bf16 v[128:143], v[222:223], v[200:201], v[128:143]
    v_mfma_f32_32x32x8_bf16 v[144:159], v[222:223], v[202:203], v[144:159]
    s_nop 10
    v_pk_mul_f32 v[128:129], v[128:129], v[42:43] op_sel:[0,0] op_sel_hi:[1,0]
    v_pk_mul_f32 v[130:131], v[130:131], v[42:43] op_sel:[0,0] op_sel_hi:[1,0]
    v_pk_mul_f32 v[132:133], v[132:133], v[42:43] op_sel:[0,0] op_sel_hi:[1,0]
    v_pk_mul_f32 v[134:135], v[134:135], v[42:43] op_sel:[0,0] op_sel_hi:[1,0]
    v_pk_mul_f32 v[136:137], v[136:137], v[42:43] op_sel:[0,0] op_sel_hi:[1,0]
    v_pk_mul_f32 v[138:139], v[138:139], v[42:43] op_sel:[0,0] op_sel_hi:[1,0]
    v_pk_mul_f32 v[140:141], v[140:141], v[42:43] op_sel:[0,0] op_sel_hi:[1,0]
    v_pk_mul_f32 v[142:143], v[142:143], v[42:43] op_sel:[0,0] op_sel_hi:[1,0]
    v_cvt_pk_bf16_f32 v128, v128, v129
    v_cvt_pk_bf16_f32 v129, v130, v131
    v_cvt_pk_bf16_f32 v130, v132, v133
    v_cvt_pk_bf16_f32 v131, v134, v135
    v_cvt_pk_bf16_f32 v132, v136, v137
    v_cvt_pk_bf16_f32 v133, v138, v139
    v_cvt_pk_bf16_f32 v134, v140, v141
    v_cvt_pk_bf16_f32 v135, v142, v143
    v_pk_max_i16 v128, v128, 0
    v_pk_max_i16 v129, v129, 0
    v_pk_max_i16 v130, v130, 0
    v_pk_max_i16 v131, v131, 0
    v_pk_max_i16 v132, v132, 0
    v_pk_max_i16 v133, v133, 0
    v_pk_max_i16 v134, v134, 0
    v_pk_max_i16 v135, v135, 0
    buffer_load_dword v239, v36, s[88:91], 0 offen sc1
    v_pk_mul_f32 v[144:145], v[144:145], v[42:43] op_sel:[0,1] op_sel_hi:[1,1]
    v_pk_mul_f32 v[146:147], v[146:147], v[42:43] op_sel:[0,1] op_sel_hi:[1,1]
    v_pk_mul_f32 v[148:149], v[148:149], v[42:43] op_sel:[0,1] op_sel_hi:[1,1]
    v_pk_mul_f32 v[150:151], v[150:151], v[42:43] op_sel:[0,1] op_sel_hi:[1,1]
    v_pk_mul_f32 v[152:153], v[152:153], v[42:43] op_sel:[0,1] op_sel_hi:[1,1]
    v_pk_mul_f32 v[154:155], v[154:155], v[42:43] op_sel:[0,1] op_sel_hi:[1,1]
    v_pk_mul_f32 v[156:157], v[156:157], v[42:43] op_sel:[0,1] op_sel_hi:[1,1]
    v_pk_mul_f32 v[158:159], v[158:159], v[42:43] op_sel:[0,1] op_sel_hi:[1,1]
    v_cvt_pk_bf16_f32 v144, v144, v145
    v_cvt_pk_bf16_f32 v145, v146, v147
    v_cvt_pk_bf16_f32 v146, v148, v149
    v_cvt_pk_bf16_f32 v147, v150, v151
    v_cvt_pk_bf16_f32 v148, v152, v153
    v_cvt_pk_bf16_f32 v149, v154, v155
    v_cvt_pk_bf16_f32 v150, v156, v157
    v_cvt_pk_bf16_f32 v151, v158, v159
    v_pk_max_i16 v144, v144, 0
    v_pk_max_i16 v145, v145, 0
    v_pk_max_i16 v146, v146, 0
    v_pk_max_i16 v147, v147, 0
    v_pk_max_i16 v148, v148, 0
    v_pk_max_i16 v149, v149, 0
    v_pk_max_i16 v150, v150, 0
    v_pk_max_i16 v151, v151, 0
    buffer_store_dwordx4 v[128:131], v217, s[88:91], 0 offen offset:0 sc1
    buffer_store_dwordx4 v[132:135], v217, s[88:91], 0 offen offset:2048 sc1
    s_waitcnt vmcnt(3)
    v_cmp_eq_u32 s[48:49], s96, v98
    v_cmp_eq_u32 s[50:51], s96, v102
    v_cmp_eq_u32 s[56:57], s96, v106
    v_cmp_eq_u32 s[58:59], s96, v110
    v_cmp_eq_u32 s[60:61], s96, v114
    v_cmp_eq_u32 s[62:63], s96, v118
    v_cmp_eq_u32 s[70:71], s96, v122
    v_cmp_eq_u32 s[46:47], s96, v126
    s_bcnt1_i32_b64 s48, s[48:49]
    s_bcnt1_i32_b64 s50, s[50:51]
    s_bcnt1_i32_b64 s56, s[56:57]
    s_bcnt1_i32_b64 s58, s[58:59]
    s_bcnt1_i32_b64 s60, s[60:61]
    s_bcnt1_i32_b64 s62, s[62:63]
    s_bcnt1_i32_b64 s70, s[70:71]
    s_bcnt1_i32_b64 s46, s[46:47]
    s_add_u32 s48, s48, s50
    s_add_u32 s48, s48, s56
    s_add_u32 s48, s48, s58
    s_add_u32 s48, s48, s60
    s_add_u32 s48, s48, s62
    s_add_u32 s48, s48, s70
    s_add_u32 s48, s48, s46
    s_cmp_lg_u32 s48, s67
    s_cbranch_scc1 L_lb_slow
L_lb_ok:
    v_fma_f32 v120, v24, v124, v120
    v_fma_f32 v121, v24, v125, v121
    v_fma_f32 v120, -v25, v125, v120
    v_fma_f32 v121, v25, v124, v121
    v_fma_f32 v116, v24, v120, v116
    v_fma_f32 v117, v24, v121, v117
    v_fma_f32 v116, -v25, v121, v116
    v_fma_f32 v117, v25, v120, v117
    v_fma_f32 v112, v24, v116, v112
    v_fma_f32 v113, v24, v117, v113
    v_fma_f32 v112, -v25, v117, v112
    v_fma_f32 v113, v25, v116, v113
    v_fma_f32 v108, v24, v112, v108
    buffer_store_dwordx4 v[144:147], v217, s[88:91], 0 offen offset:1024 sc1
    v_fma_f32 v109, v24, v113, v109
    v_fma_f32 v108, -v25, v113, v108
    v_fma_f32 v109, v25, v112, v109
    v_fma_f32 v104, v24, v108, v104
    v_fma_f32 v105, v24, v109, v105
    v_fma_f32 v104, -v25, v109, v104
    v_fma_f32 v105, v25, v108, v105
    v_fma_f32 v100, v24, v104, v100
    v_fma_f32 v101, v24, v105, v101
    v_fma_f32 v100, -v25, v105, v100
    v_fma_f32 v101, v25, v104, v101
    v_fma_f32 v96, v24, v100, v96
    v_fma_f32 v97, v24, v101, v97
    buffer_store_dwordx4 v[148:151], v217, s[88:91], 0 offen offset:3072 sc1
    v_fma_f32 v96, -v25, v101, v96
    v_fma_f32 v97, v25, v100, v97
    v_mul_f32 v62, v28, v96
    v_mul_f32 v63, v28, v97
    v_fma_f32 v62, -v29, v97, v62
    v_fma_f32 v63, v29, v96, v63
    v_mov_b32 v60, v62
    v_mov_b32 v61, v63
    s_nop 0
    v_permlane16_swap_b32 v60, v62
    v_permlane16_swap_b32 v61, v63
    v_add_f32 v62, v60, v62
    v_add_f32 v63, v61, v63
    v_mov_b32 v60, v62
    v_mov_b32 v61, v63
    s_nop 0
    v_permlane32_swap_b32 v60, v62
    v_permlane32_swap_b32 v61, v63
    v_add_f32 v62, v60, v62
    v_add_f32 v63, v61, v63
    v_fma_f32 v60, v26, v62, v40
    v_fma_f32 v61, v26, v63, v41
    v_fma_f32 v60, -v27, v63, v60
    v_fma_f32 v61, v27, v62, v61
    v_mul_f32 v62, v30, v60
    v_mul_f32 v63, v30, v61
    v_fma_f32 v62, -v31, v61, v62
    v_fma_f32 v63, v31, v60, v63
    v_fma_f32 v64, v20, v62, v64
    v_fma_f32 v80, v20, v63, v80
    v_fma_f32 v64, -v21, v63, v64
    v_fma_f32 v80, v21, v62, v80
    v_fma_f32 v65, v20, v64, v65
    v_fma_f32 v81, v20, v80, v81
    v_fma_f32 v65, -v21, v80, v65
    v_fma_f32 v81, v21, v64, v81
    s_waitcnt vmcnt(4)
    v_cmp_ne_u32 vcc, s96, v239
    s_and_b32 s46, vcc_lo, 255
    s_cbranch_scc1 L_fa_slow
L_fa_ok:
    v_cvt_pk_bf16_f32 v44, v64, v65
    v_cvt_pk_bf16_f32 v52, -v80, -v81
    v_fma_f32 v66, v20, v65, v66
    v_fma_f32 v82, v20, v81, v82
    v_fma_f32 v66, -v21, v81, v66
    v_fma_f32 v82, v21, v65, v82
    v_fma_f32 v67, v20, v66, v67
    v_fma_f32 v83, v20, v82, v83
    v_fma_f32 v67, -v21, v82, v67
    s_add_u32 s93, s64, s32
    buffer_load_dwordx4 a[176:179], v33, s[88:91], s93 offen offset:0 sc1
    v_fma_f32 v83, v21, v66, v83
    v_cvt_pk_bf16_f32 v45, v66, v67
    v_cvt_pk_bf16_f32 v53, -v82, -v83
    v_fma_f32 v68, v20, v67, v68
    v_fma_f32 v84, v20, v83, v84
    v_fma_f32 v68, -v21, v83, v68
    v_fma_f32 v84, v21, v67, v84
    v_fma_f32 v69, v20, v68, v69
    v_fma_f32 v85, v20, v84, v85
    v_fma_f32 v69, -v21, v84, v69
    buffer_load_dwordx4 a[180:183], v33, s[88:91], s93 offen offset:1024 sc1
    v_fma_f32 v85, v21, v68, v85
    v_cvt_pk_bf16_f32 v46, v68, v69
    v_cvt_pk_bf16_f32 v54, -v84, -v85
    v_fma_f32 v70, v20, v69, v70
    v_fma_f32 v86, v20, v85, v86
    v_fma_f32 v70, -v21, v85, v70
    v_fma_f32 v86, v21, v69, v86
    v_fma_f32 v71, v20, v70, v71
    v_fma_f32 v87, v20, v86, v87
    v_fma_f32 v71, -v21, v86, v71
    buffer_load_dwordx4 a[184:187], v33, s[88:91], s93 offen offset:2048 sc1
    v_fma_f32 v87, v21, v70, v87
    v_cvt_pk_bf16_f32 v47, v70, v71
    v_cvt_pk_bf16_f32 v55, -v86, -v87
    ds_write_b128 v252, v[44:47]
    ds_write_b128 v252, v[52:55] offset:2048
    v_fma_f32 v72, v20, v71, v72
    v_fma_f32 v88, v20, v87, v88
    v_fma_f32 v72, -v21, v87, v72
    v_fma_f32 v88, v21, v71, v88
    v_fma_f32 v73, v20, v72, v73
    buffer_load_dwordx4 a[188:191], v33, s[88:91], s93 offen offset:3072 sc1
    v_fma_f32 v89, v20, v88, v89
    v_fma_f32 v73, -v21, v88, v73
    v_fma_f32 v89, v21, v72, v89
    v_cvt_pk_bf16_f32 v48, v72, v73
    v_cvt_pk_bf16_f32 v56, -v88, -v89
    v_fma_f32 v74, v20, v73, v74
    v_fma_f32 v90, v20, v89, v90
    v_fma_f32 v74, -v21, v89, v74
    v_fma_f32 v90, v21, v73, v90
    s_xor_b32 s93, s93, 4096
    buffer_load_dwordx4 a[192:195], v33, s[88:91], s93 offen offset:0 sc1
    v_fma_f32 v75, v20, v74, v75
    v_fma_f32 v91, v20, v90, v91
    v_fma_f32 v75, -v21, v90, v75
    v_fma_f32 v91, v21, v74, v91
    v_cvt_pk_bf16_f32 v49, v74, v75
    v_cvt_pk_bf16_f32 v57, -v90, -v91
    v_fma_f32 v76, v20, v75, v76
    v_fma_f32 v92, v20, v91, v92
    v_fma_f32 v76, -v21, v91, v76
    v_fma_f32 v92, v21, v75, v92
    buffer_load_dwordx4 a[196:199], v33, s[88:91], s93 offen offset:1024 sc1
    v_fma_f32 v77, v20, v76, v77
    v_fma_f32 v93, v20, v92, v93
    v_fma_f32 v77, -v21, v92, v77
    v_fma_f32 v93, v21, v76, v93
    v_cvt_pk_bf16_f32 v50, v76, v77
    v_cvt_pk_bf16_f32 v58, -v92, -v93
    v_fma_f32 v78, v20, v77, v78
    v_fma_f32 v94, v20, v93, v94
    v_fma_f32 v78, -v21, v93, v78
    v_fma_f32 v94, v21, v77, v94
    buffer_load_dwordx4 a[200:203], v33, s[88:91], s93 offen offset:2048 sc1
    v_fma_f32 v79, v20, v78, v79
    v_fma_f32 v95, v20, v94, v95
    v_fma_f32 v79, -v21, v94, v79
    v_fma_f32 v95, v21, v78, v95
    v_cvt_pk_bf16_f32 v51, v78, v79
    v_cvt_pk_bf16_f32 v59, -v94, -v95
    ds_write_b128 v253, v[48:51]
    ds_write_b128 v253, v[56:59] offset:2048
    v_xor_b32 v61, 544, v254
    v_xor_b32 v62, 64, v254
    buffer_load_dwordx4 a[204:207], v33, s[88:91], s93 offen offset:3072 sc1
    v_xor_b32 v63, 64, v61
    s_movk_i32 s14, 8192
    ds_read_b64_tr_b16 v[64:65], v254 offset:0
    ds_read_b64_tr_b16 v[66:67], v61 offset:0
    ds_read_b64_tr_b16 v[68:69], v62 offset:0
    ds_read_b64_tr_b16 v[70:71], v63 offset:0
    ds_read_b64_tr_b16 v[72:73], v254 offset:2048
    ds_read_b64_tr_b16 v[74:75], v61 offset:2048
    ds_read_b64_tr_b16 v[76:77], v62 offset:2048
    ds_read_b64_tr_b16 v[78:79], v63 offset:2048
    s_waitcnt lgkmcnt(0)
    buffer_store_dwordx4 v[64:67], v242, s[88:91], 0 offen offset:0 sc1
    buffer_store_dwordx4 v[68:71], v242, s[88:91], 0 offen offset:1024 sc1
    buffer_store_dwordx4 v[72:75], v242, s[88:91], s14 offen offset:0 sc1
    buffer_store_dwordx4 v[76:79], v242, s[88:91], s14 offen offset:1024 sc1
    s_waitcnt vmcnt(11)
    v_mfma_f32_32x32x16_bf16 v[96:111], a[0:3], a[176:179], 0
    s_add_u32 s93, s64, s33
    buffer_load_dwordx4 a[208:211], v33, s[88:91], s93 offen offset:0 sc1
    v_lshlrev_b32 v35, 16, v35
    v_lshlrev_b32 v20, 16, v38
    v_mfma_f32_32x32x16_bf16 v[128:143], a[4:7], a[176:179], 0
    v_add_u32 v234, s94, v232
    v_xor_b32 v235, 64, v234
    ds_read_b64_tr_b16 a[64:65], v234 offset:32768
    ds_read_b64_tr_b16 a[66:67], v234 offset:33792
    s_waitcnt vmcnt(11)
    v_mfma_f32_32x32x16_bf16 v[112:127], a[0:3], a[180:183], 0
    buffer_load_dwordx4 a[212:215], v33, s[88:91], s93 offen offset:1024 sc1
    ds_read_b64_tr_b16 a[68:69], v235 offset:32768
    ds_read_b64_tr_b16 a[70:71], v235 offset:33792
    ds_read_b64_tr_b16 a[72:73], v234 offset:34816
    v_mfma_f32_32x32x16_bf16 v[144:159], a[4:7], a[180:183], 0
    ds_read_b64_tr_b16 a[74:75], v234 offset:35840
    ds_read_b64_tr_b16 a[76:77], v235 offset:34816
    ds_read_b64_tr_b16 a[78:79], v235 offset:35840
    ds_read_b64_tr_b16 a[80:81], v234 offset:36864
    s_waitcnt vmcnt(11)
    v_mfma_f32_32x32x16_bf16 v[96:111], a[8:11], a[184:187], v[96:111]
    buffer_load_dwordx4 a[216:219], v33, s[88:91], s93 offen offset:2048 sc1
    ds_read_b64_tr_b16 a[82:83], v234 offset:37888
    ds_read_b64_tr_b16 a[84:85], v235 offset:36864
    ds_read_b64_tr_b16 a[86:87], v235 offset:37888
    v_mfma_f32_32x32x16_bf16 v[128:143], a[12:15], a[184:187], v[128:143]
    ds_read_b64_tr_b16 a[88:89], v234 offset:38912
    ds_read_b64_tr_b16 a[90:91], v234 offset:39936
    ds_read_b64_tr_b16 a[92:93], v235 offset:38912
    ds_read_b64_tr_b16 a[94:95], v235 offset:39936
    s_waitcnt vmcnt(11)
    v_mfma_f32_32x32x16_bf16 v[112:127], a[8:11], a[188:191], v[112:127]
    buffer_load_dwordx4 a[220:223], v33, s[88:91], s93 offen offset:3072 sc1
    v_and_b32 v21, 0xffff0000, v38
    v_lshlrev_b32 v22, 16, v39
    v_and_b32 v23, 0xffff0000, v39
    v_mfma_f32_32x32x16_bf16 v[144:159], a[12:15], a[188:191], v[144:159]
    v_mov_b32_dpp v24, v34 row_newbcast:0 row_mask:0xf bank_mask:0xf
    v_mov_b32_dpp v25, v35 row_newbcast:0 row_mask:0xf bank_mask:0xf
    v_lshlrev_b32 v4, 16, v3
    v_and_b32 v5, 0xffff0000, v3
    s_waitcnt vmcnt(11)
    v_mfma_f32_32x32x16_bf16 v[96:111], a[16:19], a[192:195], v[96:111]
    s_xor_b32 s93, s93, 4096
    buffer_load_dwordx4 a[224:227], v33, s[88:91], s93 offen offset:0 sc1
    v_and_b32 v3, 0xffff0000, v2
    v_lshlrev_b32 v2, 16, v2
    v_mfma_f32_32x32x16_bf16 v[128:143], a[20:23], a[192:195], v[128:143]
    v_add_f32 v88, v2, v25
    v_add_f32 v89, v3, v25
    v_add_f32 v90, v4, v25
    v_add_f32 v91, v5, v25
    s_waitcnt vmcnt(11)
    v_mfma_f32_32x32x16_bf16 v[112:127], a[16:19], a[196:199], v[112:127]
    buffer_load_dwordx4 a[228:231], v33, s[88:91], s93 offen offset:1024 sc1
    v_cvt_pk_bf16_f32 v92, v88, v89
    v_cvt_pk_bf16_f32 v93, v90, v91
    v_lshlrev_b32 v88, 16, v92
    v_mfma_f32_32x32x16_bf16 v[144:159], a[20:23], a[196:199], v[144:159]
    v_and_b32 v89, 0xffff0000, v92
    v_lshlrev_b32 v90, 16, v93
    v_and_b32 v91, 0xffff0000, v93
    v_mul_f32 v88, v88, v24
    s_waitcnt vmcnt(11)
    v_mfma_f32_32x32x16_bf16 v[96:111], a[24:27], a[200:203], v[96:111]
    buffer_load_dwordx4 a[232:235], v33, s[88:91], s93 offen offset:2048 sc1
    v_mul_f32 v89, v89, v24
    v_mul_f32 v90, v90, v24
    v_mul_f32 v91, v91, v24
    v_mfma_f32_32x32x16_bf16 v[128:143], a[28:31], a[200:203], v[128:143]
    v_cvt_pk_bf16_f32 v92, v88, v89
    v_cvt_pk_bf16_f32 v93, v90, v91
    v_lshlrev_b32 v88, 16, v92
    v_and_b32 v89, 0xffff0000, v92
    s_waitcnt vmcnt(11)
    v_mfma_f32_32x32x16_bf16 v[112:127], a[24:27], a[204:207], v[112:127]
    buffer_load_dwordx4 a[236:239], v33, s[88:91], s93 offen offset:3072 sc1
    v_lshlrev_b32 v90, 16, v93
    v_and_b32 v91, 0xffff0000, v93
    v_mul_f32 v88, v88, v20
    v_mfma_f32_32x32x16_bf16 v[144:159], a[28:31], a[204:207], v[144:159]
    s_waitcnt vmcnt(8)
    buffer_store_dword v251, v243, s[88:91], 0 offen offset:128 sc1
    v_mul_f32 v89, v89, v21
    v_mul_f32 v90, v90, v22
    v_mul_f32 v91, v91, v23
    s_waitcnt vmcnt(8)
    v_mfma_f32_32x32x16_bf16 v[96:111], a[32:35], a[208:211], v[96:111]
    s_add_u32 s93, s65, s32
    buffer_load_dwordx4 a[240:243], v33, s[88:91], s93 offen offset:0 sc1
    s_add_u32 m0, s98, 8192
    s_add_u32 s92, s3, 0
    buffer_load_dwordx4 v228, s[80:83], s92 offen offset:0 lds
    v_mfma_f32_32x32x16_bf16 v[128:143], a[36:39], a[208:211], v[128:143]
    v_cvt_pk_bf16_f32 v92, v88, v89
    v_cvt_pk_bf16_f32 v93, v90, v91
    v_lshlrev_b32 v88, 16, v92
    v_and_b32 v89, 0xffff0000, v92
    s_waitcnt vmcnt(9)
    v_mfma_f32_32x32x16_bf16 v[112:127], a[32:35], a[212:215], v[112:127]
    buffer_load_dwordx4 a[244:247], v33, s[88:91], s93 offen offset:1024 sc1
    buffer_load_dwordx4 v229, s[80:83], s92 offen offset:1024 lds
    v_lshlrev_b32 v90, 16, v93
    v_and_b32 v91, 0xffff0000, v93
    v_mfma_f32_32x32x16_bf16 v[144:159], a[36:39], a[212:215], v[144:159]
    v_add_f32 v2, v2, v88
    v_add_f32 v3, v3, v89
    v_add_f32 v4, v4, v90
    v_add_f32 v5, v5, v91
    s_waitcnt vmcnt(10)
    v_mfma_f32_32x32x16_bf16 v[96:111], a[40:43], a[216:219], v[96:111]
    buffer_load_dwordx4 a[248:251], v33, s[88:91], s93 offen offset:2048 sc1
    buffer_load_dwordx4 v230, s[80:83], s92 offen offset:2048 lds
    v_mov_b32_dpp v24, v34 row_newbcast:1 row_mask:0xf bank_mask:0xf
    v_mov_b32_dpp v25, v35 row_newbcast:1 row_mask:0xf bank_mask:0xf
    v_mfma_f32_32x32x16_bf16 v[128:143], a[44:47], a[216:219], v[128:143]
    v_lshlrev_b32 v8, 16, v7
    v_and_b32 v9, 0xffff0000, v7
    v_and_b32 v7, 0xffff0000, v6
    v_lshlrev_b32 v6, 16, v6
    s_waitcnt vmcnt(11)
    v_mfma_f32_32x32x16_bf16 v[112:127], a[40:43], a[220:223], v[112:127]
    buffer_load_dwordx4 a[252:255], v33, s[88:91], s93 offen offset:3072 sc1
    buffer_load_dwordx4 v231, s[80:83], s92 offen offset:3072 lds
    v_add_f32 v88, v6, v25
    v_add_f32 v89, v7, v25
    v_mfma_f32_32x32x16_bf16 v[144:159], a[44:47], a[220:223], v[144:159]
    v_add_f32 v90, v8, v25
    v_add_f32 v91, v9, v25
    v_cvt_pk_bf16_f32 v92, v88, v89
    v_cvt_pk_bf16_f32 v93, v90, v91
    s_waitcnt vmcnt(12)
    v_mfma_f32_32x32x16_bf16 v[96:111], a[48:51], a[224:227], v[96:111]
    s_xor_b32 s93, s93, 4096
    buffer_load_dwordx4 a[176:179], v33, s[88:91], s93 offen offset:0 sc1
    v_lshlrev_b32 v88, 16, v92
    v_and_b32 v89, 0xffff0000, v92
    v_mfma_f32_32x32x16_bf16 v[128:143], a[52:55], a[224:227], v[128:143]
    s_add_u32 m0, s98, 12288
    s_add_u32 s92, s3, 32768
    buffer_load_dwordx4 v228, s[80:83], s92 offen offset:0 lds
    v_lshlrev_b32 v90, 16, v93
    s_waitcnt vmcnt(13)
    v_mfma_f32_32x32x16_bf16 v[112:127], a[48:51], a[228:231], v[112:127]
    buffer_load_dwordx4 a[180:183], v33, s[88:91], s93 offen offset:1024 sc1
    v_and_b32 v91, 0xffff0000, v93
    v_mul_f32 v88, v88, v24
    v_mul_f32 v89, v89, v24
    v_mfma_f32_32x32x16_bf16 v[144:159], a[52:55], a[228:231], v[144:159]
    buffer_load_dwordx4 v229, s[80:83], s92 offen offset:1024 lds
    v_mul_f32 v90, v90, v24
    v_mul_f32 v91, v91, v24
    v_cvt_pk_bf16_f32 v92, v88, v89
    s_waitcnt vmcnt(14)
    v_mfma_f32_32x32x16_bf16 v[96:111], a[56:59], a[232:235], v[96:111]
    buffer_load_dwordx4 a[184:187], v33, s[88:91], s93 offen offset:2048 sc1
    v_cvt_pk_bf16_f32 v93, v90, v91
    v_lshlrev_b32 v88, 16, v92
    v_and_b32 v89, 0xffff0000, v92
    v_mfma_f32_32x32x16_bf16 v[128:143], a[60:63], a[232:235], v[128:143]
    buffer_load_dwordx4 v230, s[80:83], s92 offen offset:2048 lds
    v_lshlrev_b32 v90, 16, v93
    v_and_b32 v91, 0xffff0000, v93
    v_mul_f32 v88, v88, v20
    s_waitcnt vmcnt(15)
    v_mfma_f32_32x32x16_bf16 v[112:127], a[56:59], a[236:239], v[112:127]
    buffer_load_dwordx4 a[188:191], v33, s[88:91], s93 offen offset:3072 sc1
    v_mul_f32 v89, v89, v21
    v_mul_f32 v90, v90, v22
    v_mul_f32 v91, v91, v23
    v_mfma_f32_32x32x16_bf16 v[144:159], a[60:63], a[236:239], v[144:159]
    buffer_load_dwordx4 v231, s[80:83], s92 offen offset:3072 lds
    v_cvt_pk_bf16_f32 v92, v88, v89
    v_cvt_pk_bf16_f32 v93, v90, v91
    v_lshlrev_b32 v88, 16, v92
    s_waitcnt vmcnt(15)
    v_mfma_f32_32x32x16_bf16 v[160:175], a[0:3], a[240:243], 0
    s_add_u32 s93, s65, s33
    buffer_load_dwordx4 a[192:195], v33, s[88:91], s93 offen offset:0 sc1
    v_and_b32 v89, 0xffff0000, v92
    v_lshlrev_b32 v90, 16, v93
    v_mfma_f32_32x32x16_bf16 v[192:207], a[4:7], a[240:243], 0
    v_add_u32 v234, s94, v232
    v_add_u32 v234, 65536, v234
    v_xor_b32 v235, 64, v234
    ds_read_b64_tr_b16 a[96:97], v234 offset:0
    s_waitcnt vmcnt(14)
    v_mfma_f32_32x32x16_bf16 v[176:191], a[0:3], a[244:247], 0
    buffer_load_dwordx4 a[196:199], v33, s[88:91], s93 offen offset:1024 sc1
    ds_read_b64_tr_b16 a[98:99], v234 offset:1024
    ds_read_b64_tr_b16 a[100:101], v235 offset:0
    ds_read_b64_tr_b16 a[102:103], v235 offset:1024
    v_mfma_f32_32x32x16_bf16 v[208:223], a[4:7], a[244:247], 0
    ds_read_b64_tr_b16 a[104:105], v234 offset:2048
    ds_read_b64_tr_b16 a[106:107], v234 offset:3072
    ds_read_b64_tr_b16 a[108:109], v235 offset:2048
    ds_read_b64_tr_b16 a[110:111], v235 offset:3072
    s_waitcnt vmcnt(13)
    v_mfma_f32_32x32x16_bf16 v[160:175], a[8:11], a[248:251], v[160:175]
    buffer_load_dwordx4 a[200:203], v33, s[88:91], s93 offen offset:2048 sc1
    v_and_b32 v91, 0xffff0000, v93
    v_add_f32 v6, v6, v88
    v_add_f32 v7, v7, v89
    v_mfma_f32_32x32x16_bf16 v[192:207], a[12:15], a[248:251], v[192:207]
    v_add_f32 v8, v8, v90
    v_add_f32 v9, v9, v91
    v_mov_b32_dpp v24, v34 row_newbcast:2 row_mask:0xf bank_mask:0xf
    v_mov_b32_dpp v25, v35 row_newbcast:2 row_mask:0xf bank_mask:0xf
    s_waitcnt vmcnt(12)
    v_mfma_f32_32x32x16_bf16 v[176:191], a[8:11], a[252:255], v[176:191]
    buffer_load_dwordx4 a[204:207], v33, s[88:91], s93 offen offset:3072 sc1
    v_lshlrev_b32 v12, 16, v11
    v_and_b32 v13, 0xffff0000, v11
    v_and_b32 v11, 0xffff0000, v10
    v_mfma_f32_32x32x16_bf16 v[208:223], a[12:15], a[252:255], v[208:223]
    v_lshlrev_b32 v10, 16, v10
    v_add_f32 v88, v10, v25
    v_add_f32 v89, v11, v25
    v_add_f32 v90, v12, v25
    s_waitcnt vmcnt(11)
    v_mfma_f32_32x32x16_bf16 v[160:175], a[16:19], a[176:179], v[160:175]
    buffer_load_dword v239, v36, s[88:91], 0 offen offset:128 sc1
    s_xor_b32 s93, s93, 4096
    buffer_load_dwordx4 a[208:211], v33, s[88:91], s93 offen offset:0 sc1
    v_add_u32 v234, s98, v233
    v_mfma_f32_32x32x16_bf16 v[192:207], a[20:23], a[176:179], v[192:207]
    v_xor_b32 v235, 32, v234
    v_xor_b32 v236, 64, v234
    v_xor_b32 v237, 96, v234
    ds_read_b128 a[112:115], v234 offset:0
    s_waitcnt vmcnt(11)
    v_mfma_f32_32x32x16_bf16 v[176:191], a[16:19], a[180:183], v[176:191]
    buffer_load_dwordx4 a[212:215], v33, s[88:91], s93 offen offset:1024 sc1
    ds_read_b128 a[116:119], v234 offset:4096
    ds_read_b128 a[120:123], v235 offset:0
    ds_read_b128 a[124:127], v235 offset:4096
    v_mfma_f32_32x32x16_bf16 v[208:223], a[20:23], a[180:183], v[208:223]
    ds_read_b128 a[128:131], v236 offset:0
    ds_read_b128 a[132:135], v236 offset:4096
    ds_read_b128 a[136:139], v237 offset:0
    ds_read_b128 a[140:143], v237 offset:4096
    s_waitcnt vmcnt(10)
    v_mfma_f32_32x32x16_bf16 v[160:175], a[24:27], a[184:187], v[160:175]
    buffer_load_dwordx4 a[216:219], v33, s[88:91], s93 offen offset:2048 sc1
    v_add_u32 v234, s98, v233
    v_xor_b32 v235, 32, v234
    v_xor_b32 v236, 64, v234
    v_mfma_f32_32x32x16_bf16 v[192:207], a[28:31], a[184:187], v[192:207]
    v_xor_b32 v237, 96, v234
    s_waitcnt vmcnt(8)
    ds_read_b128 a[144:147], v234 offset:8192
    ds_read_b128 a[148:151], v234 offset:12288
    ds_read_b128 a[152:155], v235 offset:8192
    v_mfma_f32_32x32x16_bf16 v[176:191], a[24:27], a[188:191], v[176:191]
    buffer_load_dwordx4 a[220:223], v33, s[88:91], s93 offen offset:3072 sc1
    ds_read_b128 a[156:159], v235 offset:12288
    ds_read_b128 a[160:163], v236 offset:8192
    ds_read_b128 a[164:167], v236 offset:12288
    v_mfma_f32_32x32x16_bf16 v[208:223], a[28:31], a[188:191], v[208:223]
    ds_read_b128 a[168:171], v237 offset:8192
    ds_read_b128 a[172:175], v237 offset:12288
    v_add_f32 v91, v13, v25
    v_cvt_pk_bf16_f32 v92, v88, v89
    s_waitcnt vmcnt(8)
    v_mfma_f32_32x32x16_bf16 v[160:175], a[32:35], a[192:195], v[160:175]
    s_waitcnt vmcnt(4)
    v_cmp_ne_u32 vcc, s96, v239
    s_and_b32 s46, vcc_lo, 65535
    s_cbranch_scc1 L_fs_slow
L_fs_ok:
    s_add_u32 s93, s64, s100
    buffer_load_dwordx4 a[224:227], v33, s[88:91], s93 offen offset:0 sc1
    buffer_load_dwordx4 a[228:231], v33, s[88:91], s93 offen offset:1024 sc1
    v_mfma_f32_32x32x16_bf16 v[192:207], a[36:39], a[192:195], v[192:207]
    v_cvt_pk_bf16_f32 v93, v90, v91
    v_lshlrev_b32 v88, 16, v92
    v_and_b32 v89, 0xffff0000, v92
    v_lshlrev_b32 v90, 16, v93
    v_mfma_f32_32x32x16_bf16 v[176:191], a[32:35], a[196:199], v[176:191]
    buffer_load_dwordx4 a[232:235], v33, s[88:91], s93 offen offset:2048 sc1
    v_and_b32 v91, 0xffff0000, v93
    v_mul_f32 v88, v88, v24
    v_mul_f32 v89, v89, v24
    v_mfma_f32_32x32x16_bf16 v[208:223], a[36:39], a[196:199], v[208:223]
    v_mul_f32 v90, v90, v24
    v_mul_f32 v91, v91, v24
    v_cvt_pk_bf16_f32 v92, v88, v89
    v_cvt_pk_bf16_f32 v93, v90, v91
    v_mfma_f32_32x32x16_bf16 v[160:175], a[40:43], a[200:203], v[160:175]
    buffer_load_dwordx4 a[236:239], v33, s[88:91], s93 offen offset:3072 sc1
    v_lshlrev_b32 v88, 16, v92
    v_and_b32 v89, 0xffff0000, v92
    v_lshlrev_b32 v90, 16, v93
    v_mfma_f32_32x32x16_bf16 v[192:207], a[44:47], a[200:203], v[192:207]
    v_and_b32 v91, 0xffff0000, v93
    v_mul_f32 v88, v88, v20
    v_mul_f32 v89, v89, v21
    v_mul_f32 v90, v90, v22
    v_mfma_f32_32x32x16_bf16 v[176:191], a[40:43], a[204:207], v[176:191]
    s_xor_b32 s93, s93, 4096
    buffer_load_dwordx4 a[240:243], v33, s[88:91], s93 offen offset:0 sc1
    v_mul_f32 v91, v91, v23
    v_cvt_pk_bf16_f32 v92, v88, v89
    v_mfma_f32_32x32x16_bf16 v[208:223], a[44:47], a[204:207], v[208:223]
    v_cvt_pk_bf16_f32 v93, v90, v91
    v_lshlrev_b32 v88, 16, v92
    v_and_b32 v89, 0xffff0000, v92
    v_lshlrev_b32 v90, 16, v93
    s_waitcnt vmcnt(8)
    v_mfma_f32_32x32x16_bf16 v[160:175], a[48:51], a[208:211], v[160:175]
    buffer_load_dwordx4 a[244:247], v33, s[88:91], s93 offen offset:1024 sc1
    v_and_b32 v91, 0xffff0000, v93
    v_add_f32 v10, v10, v88
    v_add_f32 v11, v11, v89
    v_mfma_f32_32x32x16_bf16 v[192:207], a[52:55], a[208:211], v[192:207]
    v_add_f32 v12, v12, v90
    v_add_f32 v13, v13, v91
    v_mov_b32_dpp v24, v34 row_newbcast:3 row_mask:0xf bank_mask:0xf
    v_mov_b32_dpp v25, v35 row_newbcast:3 row_mask:0xf bank_mask:0xf
    s_waitcnt vmcnt(8)
    v_mfma_f32_32x32x16_bf16 v[176:191], a[48:51], a[212:215], v[176:191]
    buffer_load_dwordx4 a[248:251], v33, s[88:91], s93 offen offset:2048 sc1
    v_lshlrev_b32 v16, 16, v15
    v_and_b32 v17, 0xffff0000, v15
    v_and_b32 v15, 0xffff0000, v14
    v_mfma_f32_32x32x16_bf16 v[208:223], a[52:55], a[212:215], v[208:223]
    v_lshlrev_b32 v14, 16, v14
    v_add_f32 v88, v14, v25
    v_add_f32 v89, v15, v25
    v_add_f32 v90, v16, v25
    s_waitcnt vmcnt(8)
    v_mfma_f32_32x32x16_bf16 v[160:175], a[56:59], a[216:219], v[160:175]
    buffer_load_dwordx4 a[252:255], v33, s[88:91], s93 offen offset:3072 sc1
    v_add_f32 v91, v17, v25
    v_cvt_pk_bf16_f32 v92, v88, v89
    v_cvt_pk_bf16_f32 v93, v90, v91
    v_mfma_f32_32x32x16_bf16 v[192:207], a[60:63], a[216:219], v[192:207]
    v_lshlrev_b32 v88, 16, v92
    v_and_b32 v89, 0xffff0000, v92
    v_lshlrev_b32 v90, 16, v93
    v_and_b32 v91, 0xffff0000, v93
    s_waitcnt vmcnt(8)
    v_mfma_f32_32x32x16_bf16 v[176:191], a[56:59], a[220:223], v[176:191]
    s_add_u32 s93, s64, s101
    buffer_load_dwordx4 a[176:179], v33, s[88:91], s93 offen offset:0 sc1
    v_mul_f32 v88, v88, v24
    v_mul_f32 v89, v89, v24
    v_mfma_f32_32x32x16_bf16 v[208:223], a[60:63], a[220:223], v[208:223]
    v_mul_f32 v90, v90, v24
    v_mul_f32 v91, v91, v24
    v_cvt_pk_bf16_f32 v92, v88, v89
    v_cvt_pk_bf16_f32 v93, v90, v91
    s_waitcnt vmcnt(8) lgkmcnt(15)
    v_mfma_f32_32x32x16_bf16 v[96:111], a[64:67], a[224:227], v[96:111]
    buffer_load_dwordx4 a[180:183], v33, s[88:91], s93 offen offset:1024 sc1
    v_lshlrev_b32 v88, 16, v92
    v_and_b32 v89, 0xffff0000, v92
    v_lshlrev_b32 v90, 16, v93
    v_mfma_f32_32x32x16_bf16 v[128:143], a[68:71], a[224:227], v[128:143]
    v_and_b32 v91, 0xffff0000, v93
    v_mul_f32 v88, v88, v20
    v_mul_f32 v89, v89, v21
    v_mul_f32 v90, v90, v22
    s_waitcnt vmcnt(8)
    v_mfma_f32_32x32x16_bf16 v[112:127], a[64:67], a[228:231], v[112:127]
    buffer_load_dwordx4 a[184:187], v33, s[88:91], s93 offen offset:2048 sc1
    v_mul_f32 v91, v91, v23
    v_cvt_pk_bf16_f32 v92, v88, v89
    v_cvt_pk_bf16_f32 v93, v90, v91
    v_mfma_f32_32x32x16_bf16 v[144:159], a[68:71], a[228:231], v[144:159]
    v_lshlrev_b32 v88, 16, v92
    v_and_b32 v89, 0xffff0000, v92
    v_lshlrev_b32 v90, 16, v93
    v_and_b32 v91, 0xffff0000, v93
    s_waitcnt vmcnt(8)
    v_mfma_f32_32x32x16_bf16 v[96:111], a[72:75], a[232:235], v[96:111]
    buffer_load_dwordx4 a[188:191], v33, s[88:91], s93 offen offset:3072 sc1
    v_add_f32 v14, v14, v88
    v_add_f32 v15, v15, v89
    v_add_f32 v16, v16, v90
    v_mfma_f32_32x32x16_bf16 v[128:143], a[76:79], a[232:235], v[128:143]
    v_add_f32 v17, v17, v91
    s_waitcnt vmcnt(8)
    v_mfma_f32_32x32x16_bf16 v[112:127], a[72:75], a[236:239], v[112:127]
    s_add_u32 s93, s64, s66
    buffer_load_dwordx4 a[192:195], v33, s[88:91], s93 offen offset:0 sc1
    v_mfma_f32_32x32x16_bf16 v[144:159], a[76:79], a[236:239], v[144:159]
    s_waitcnt vmcnt(8)
    v_mfma_f32_32x32x16_bf16 v[96:111], a[80:83], a[240:243], v[96:111]
    buffer_load_dwordx4 a[196:199], v33, s[88:91], s93 offen offset:1024 sc1
    v_mfma_f32_32x32x16_bf16 v[128:143], a[84:87], a[240:243], v[128:143]
    s_waitcnt vmcnt(8)
    v_mfma_f32_32x32x16_bf16 v[112:127], a[80:83], a[244:247], v[112:127]
    buffer_load_dwordx4 a[200:203], v33, s[88:91], s93 offen offset:2048 sc1
    v_mfma_f32_32x32x16_bf16 v[144:159], a[84:87], a[244:247], v[144:159]
    s_waitcnt vmcnt(8)
    v_mfma_f32_32x32x16_bf16 v[96:111], a[88:91], a[248:251], v[96:111]
    buffer_load_dwordx4 a[204:207], v33, s[88:91], s93 offen offset:3072 sc1
    v_mfma_f32_32x32x16_bf16 v[128:143], a[92:95], a[248:251], v[128:143]
    s_waitcnt vmcnt(8)
    v_mfma_f32_32x32x16_bf16 v[112:127], a[88:91], a[252:255], v[112:127]
    s_xor_b32 s93, s93, 4096
    buffer_load_dwordx4 a[208:211], v33, s[88:91], s93 offen offset:0 sc1
    v_mfma_f32_32x32x16_bf16 v[144:159], a[92:95], a[252:255], v[144:159]
    s_waitcnt vmcnt(8)
    v_mfma_f32_32x32x16_bf16 v[96:111], a[96:99], a[176:179], v[96:111]
    buffer_load_dwordx4 a[212:215], v33, s[88:91], s93 offen offset:1024 sc1
    v_mfma_f32_32x32x16_bf16 v[128:143], a[100:103], a[176:179], v[128:143]
    s_waitcnt vmcnt(8)
    v_mfma_f32_32x32x16_bf16 v[112:127], a[96:99], a[180:183], v[112:127]
    buffer_load_dwordx4 a[216:219], v33, s[88:91], s93 offen offset:2048 sc1
    v_mov_b32 v80, s96
    v_lshrrev_b32 v81, 8, v80
    v_lshrrev_b32 v82, 16, v80
    v_mfma_f32_32x32x16_bf16 v[144:159], a[100:103], a[180:183], v[144:159]
    v_lshrrev_b32 v83, 24, v80
    s_movk_i32 s15, 0xff
    s_waitcnt vmcnt(8)
    v_mfma_f32_32x32x16_bf16 v[96:111], a[104:107], a[184:187], v[96:111]
    buffer_load_dwordx4 a[220:223], v33, s[88:91], s93 offen offset:3072 sc1
    v_mfma_f32_32x32x16_bf16 v[128:143], a[108:111], a[184:187], v[128:143]
    s_waitcnt vmcnt(8)
    v_mfma_f32_32x32x16_bf16 v[112:127], a[104:107], a[188:191], v[112:127]
    s_xor_b32 s93, s66, 8192
    s_add_u32 s93, s93, s64
    buffer_load_dwordx4 a[224:227], v33, s[88:91], s93 offen offset:0 sc1
    v_mfma_f32_32x32x16_bf16 v[144:159], a[108:111], a[188:191], v[144:159]
    s_waitcnt vmcnt(8) lgkmcnt(0)
    v_mfma_f32_32x32x16_bf16 v[96:111], a[112:115], a[192:195], v[96:111]
    buffer_load_dwordx4 a[228:231], v33, s[88:91], s93 offen offset:1024 sc1
    v_mfma_f32_32x32x16_bf16 v[128:143], a[116:119], a[192:195], v[128:143]
    s_waitcnt vmcnt(8)
    v_mfma_f32_32x32x16_bf16 v[112:127], a[112:115], a[196:199], v[112:127]
    buffer_load_dwordx4 a[232:235], v33, s[88:91], s93 offen offset:2048 sc1
    v_mfma_f32_32x32x16_bf16 v[144:159], a[116:119], a[196:199], v[144:159]
    s_waitcnt vmcnt(8)
    v_mfma_f32_32x32x16_bf16 v[96:111], a[120:123], a[200:203], v[96:111]
    buffer_load_dwordx4 a[236:239], v33, s[88:91], s93 offen offset:3072 sc1
    v_mfma_f32_32x32x16_bf16 v[128:143], a[124:127], a[200:203], v[128:143]
    s_waitcnt vmcnt(8)
    v_mfma_f32_32x32x16_bf16 v[112:127], a[120:123], a[204:207], v[112:127]
    s_xor_b32 s93, s93, 4096
    buffer_load_dwordx4 a[240:243], v33, s[88:91], s93 offen offset:0 sc1
    v_mfma_f32_32x32x16_bf16 v[144:159], a[124:127], a[204:207], v[144:159]
    s_waitcnt vmcnt(8)
    v_mfma_f32_32x32x16_bf16 v[96:111], a[128:131], a[208:211], v[96:111]
    buffer_load_dwordx4 a[244:247], v33, s[88:91], s93 offen offset:1024 sc1
    v_mfma_f32_32x32x16_bf16 v[128:143], a[132:135], a[208:211], v[128:143]
    s_waitcnt vmcnt(8)
    v_mfma_f32_32x32x16_bf16 v[112:127], a[128:131], a[212:215], v[112:127]
    buffer_load_dwordx4 a[248:251], v33, s[88:91], s93 offen offset:2048 sc1
    v_mfma_f32_32x32x16_bf16 v[144:159], a[132:135], a[212:215], v[144:159]
    s_waitcnt vmcnt(8)
    v_mfma_f32_32x32x16_bf16 v[96:111], a[136:139], a[216:219], v[96:111]
    buffer_load_dwordx4 a[252:255], v33, s[88:91], s93 offen offset:3072 sc1
    v_mfma_f32_32x32x16_bf16 v[128:143], a[140:143], a[216:219], v[128:143]
    s_waitcnt vmcnt(8)
    v_mfma_f32_32x32x16_bf16 v[112:127], a[136:139], a[220:223], v[112:127]
    s_add_u32 s93, s65, s100
    buffer_load_dwordx4 a[176:179], v33, s[88:91], s93 offen offset:0 sc1
    v_mfma_f32_32x32x16_bf16 v[144:159], a[140:143], a[220:223], v[144:159]
    s_waitcnt vmcnt(8)
    v_mfma_f32_32x32x16_bf16 v[96:111], a[144:147], a[224:227], v[96:111]
    buffer_load_dwordx4 a[180:183], v33, s[88:91], s93 offen offset:1024 sc1
    s_waitcnt vmcnt(7)
    v_mfma_f32_32x32x16_bf16 v[96:111], a[152:155], a[232:235], v[96:111]
    buffer_load_dwordx4 a[184:187], v33, s[88:91], s93 offen offset:2048 sc1
    s_waitcnt vmcnt(6)
    v_mfma_f32_32x32x16_bf16 v[96:111], a[160:163], a[240:243], v[96:111]
    buffer_load_dwordx4 a[188:191], v33, s[88:91], s93 offen offset:3072 sc1
    s_waitcnt vmcnt(5)
    v_mfma_f32_32x32x16_bf16 v[96:111], a[168:171], a[248:251], v[96:111]
    s_xor_b32 s93, s93, 4096
    buffer_load_dwordx4 a[192:195], v33, s[88:91], s93 offen offset:0 sc1
    v_mfma_f32_32x32x16_bf16 v[128:143], a[148:151], a[224:227], v[128:143]
    buffer_load_dwordx4 a[196:199], v33, s[88:91], s93 offen offset:1024 sc1
    v_mfma_f32_32x32x16_bf16 v[128:143], a[156:159], a[232:235], v[128:143]
    buffer_load_dwordx4 a[200:203], v33, s[88:91], s93 offen offset:2048 sc1
    s_nop 5
    ds_write_b128 v246, v[96:99] offset:0
    v_mfma_f32_32x32x16_bf16 v[128:143], a[164:167], a[240:243], v[128:143]
    buffer_load_dwordx4 a[204:207], v33, s[88:91], s93 offen offset:3072 sc1
    ds_write_b128 v247, v[100:103] offset:0
    v_mfma_f32_32x32x16_bf16 v[128:143], a[172:175], a[248:251], v[128:143]
    s_add_u32 s93, s65, s101
    buffer_load_dwordx4 a[208:211], v33, s[88:91], s93 offen offset:0 sc1
    v_mfma_f32_32x32x16_bf16 v[112:127], a[144:147], a[228:231], v[112:127]
    buffer_load_dwordx4 a[212:215], v33, s[88:91], s93 offen offset:1024 sc1
    ds_write_b128 v248, v[104:107] offset:0
    v_mfma_f32_32x32x16_bf16 v[112:127], a[152:155], a[236:239], v[112:127]
    buffer_load_dwordx4 a[216:219], v33, s[88:91], s93 offen offset:2048 sc1
    ds_write_b128 v249, v[108:111] offset:0
    v_mfma_f32_32x32x16_bf16 v[112:127], a[160:163], a[244:247], v[112:127]
    buffer_load_dwordx4 a[220:223], v33, s[88:91], s93 offen offset:3072 sc1
    s_nop 1
    ds_write_b128 v246, v[128:131] offset:128
    s_waitcnt vmcnt(12)
    v_mfma_f32_32x32x16_bf16 v[112:127], a[168:171], a[252:255], v[112:127]
    ds_write_b128 v247, v[132:135] offset:128
    v_mfma_f32_32x32x16_bf16 v[144:159], a[148:151], a[228:231], v[144:159]
    s_add_u32 s93, s65, s66
    buffer_load_dwordx4 a[224:227], v33, s[88:91], s93 offen offset:0 sc1
    v_mfma_f32_32x32x16_bf16 v[144:159], a[156:159], a[236:239], v[144:159]
    buffer_load_dwordx4 a[228:231], v33, s[88:91], s93 offen offset:1024 sc1
    ds_write_b128 v248, v[136:139] offset:128
    v_mfma_f32_32x32x16_bf16 v[144:159], a[164:167], a[244:247], v[144:159]
    buffer_load_dwordx4 a[232:235], v33, s[88:91], s93 offen offset:2048 sc1
    ds_write_b128 v249, v[140:143] offset:128
    v_mfma_f32_32x32x16_bf16 v[144:159], a[172:175], a[252:255], v[144:159]
    buffer_load_dwordx4 a[236:239], v33, s[88:91], s93 offen offset:3072 sc1
    ds_write_b128 v246, v[112:115] offset:8192
    s_waitcnt vmcnt(15)
    v_mfma_f32_32x32x16_bf16 v[160:175], a[64:67], a[176:179], v[160:175]
    s_xor_b32 s93, s93, 4096
    buffer_load_dwordx4 a[240:243], v33, s[88:91], s93 offen offset:0 sc1
    ds_write_b128 v247, v[116:119] offset:8192
    v_mfma_f32_32x32x16_bf16 v[192:207], a[68:71], a[176:179], v[192:207]
    buffer_load_dwordx4 a[244:247], v33, s[88:91], s93 offen offset:1024 sc1
    ds_write_b128 v248, v[120:123] offset:8192
    s_waitcnt vmcnt(16)
    v_mfma_f32_32x32x16_bf16 v[176:191], a[64:67], a[180:183], v[176:191]
    buffer_load_dwordx4 a[248:251], v33, s[88:91], s93 offen offset:2048 sc1
    ds_write_b128 v249, v[124:127] offset:8192
    v_mfma_f32_32x32x16_bf16 v[208:223], a[68:71], a[180:183], v[208:223]
    buffer_load_dwordx4 a[252:255], v33, s[88:91], s93 offen offset:3072 sc1
    ds_write_b128 v246, v[144:147] offset:8320
    s_waitcnt vmcnt(17)
    v_mfma_f32_32x32x16_bf16 v[160:175], a[72:75], a[184:187], v[160:175]
    s_xor_b32 s93, s66, 8192
    s_add_u32 s93, s93, s65
    buffer_load_dwordx4 a[176:179], v33, s[88:91], s93 offen offset:0 sc1
    ds_write_b128 v247, v[148:151] offset:8320
    v_mfma_f32_32x32x16_bf16 v[192:207], a[76:79], a[184:187], v[192:207]
    buffer_load_dwordx4 a[180:183], v33, s[88:91], s93 offen offset:1024 sc1
    ds_write_b128 v248, v[152:155] offset:8320
    s_waitcnt vmcnt(18)
    v_mfma_f32_32x32x16_bf16 v[176:191], a[72:75], a[188:191], v[176:191]
    ds_write_b128 v249, v[156:159] offset:8320
    v_mfma_f32_32x32x16_bf16 v[208:223], a[76:79], a[188:191], v[208:223]
    buffer_load_dwordx4 a[184:187], v33, s[88:91], s93 offen offset:2048 sc1
    s_waitcnt lgkmcnt(0)
    s_barrier
    ds_read_b128 v[96:99], v250 offset:0
    ds_read_b128 v[100:103], v250 offset:16384
    ds_read_b128 v[104:107], v250 offset:32768
    ds_read_b128 v[108:111], v250 offset:49152
    ds_read_b128 v[112:115], v250 offset:1024
    s_waitcnt vmcnt(18)
    v_mfma_f32_32x32x16_bf16 v[160:175], a[80:83], a[192:195], v[160:175]
    buffer_load_dwordx4 a[188:191], v33, s[88:91], s93 offen offset:3072 sc1
    ds_read_b128 v[116:119], v250 offset:17408
    ds_read_b128 v[120:123], v250 offset:33792
    ds_read_b128 v[124:127], v250 offset:50176
    ds_read_b128 v[128:131], v250 offset:2048
    ds_read_b128 v[132:135], v250 offset:18432
    ds_read_b128 v[136:139], v250 offset:34816
    v_mfma_f32_32x32x16_bf16 v[192:207], a[84:87], a[192:195], v[192:207]
    ds_read_b128 v[140:143], v250 offset:51200
    ds_read_b128 v[144:147], v250 offset:3072
    ds_read_b128 v[148:151], v250 offset:19456
    ds_read_b128 v[152:155], v250 offset:35840
    ds_read_b128 v[156:159], v250 offset:52224
    v_subrev_u32 v246, 98304, v246
    v_subrev_u32 v247, 98304, v247
    s_waitcnt vmcnt(18)
    v_mfma_f32_32x32x16_bf16 v[176:191], a[80:83], a[196:199], v[176:191]
    v_subrev_u32 v248, 98304, v248
    v_subrev_u32 v249, 98304, v249
    v_mfma_f32_32x32x16_bf16 v[208:223], a[84:87], a[196:199], v[208:223]
    s_xor_b32 s93, s93, 4096
    buffer_load_dwordx4 a[192:195], v33, s[88:91], s93 offen offset:0 sc1
    s_waitcnt lgkmcnt(12)
    v_pk_add_f32 v[96:97], v[96:97], v[100:101]
    v_pk_add_f32 v[104:105], v[104:105], v[108:109]
    v_pk_add_f32 v[98:99], v[98:99], v[102:103]
    v_pk_add_f32 v[106:107], v[106:107], v[110:111]
    v_pk_add_f32 v[96:97], v[96:97], v[104:105]
    v_pk_add_f32 v[98:99], v[98:99], v[106:107]
    v_bfi_b32 v64, s15, v80, v96
    v_bfi_b32 v65, s15, v81, v97
    v_bfi_b32 v66, s15, v82, v98
    v_bfi_b32 v67, s15, v83, v99
    buffer_store_dwordx4 v[64:67], v244, s[88:91], 0 offen offset:0 sc1
    s_waitcnt lgkmcnt(8)
    v_pk_add_f32 v[112:113], v[112:113], v[116:117]
    v_pk_add_f32 v[120:121], v[120:121], v[124:125]
    v_pk_add_f32 v[114:115], v[114:115], v[118:119]
    v_pk_add_f32 v[122:123], v[122:123], v[126:127]
    v_pk_add_f32 v[112:113], v[112:113], v[120:121]
    v_pk_add_f32 v[114:115], v[114:115], v[122:123]
    v_bfi_b32 v68, s15, v80, v112
    v_bfi_b32 v69, s15, v81, v113
    v_bfi_b32 v70, s15, v82, v114
    v_bfi_b32 v71, s15, v83, v115
    buffer_store_dwordx4 v[68:71], v244, s[88:91], 0 offen offset:1024 sc1
    s_waitcnt lgkmcnt(4)
    v_pk_add_f32 v[128:129], v[128:129], v[132:133]
    v_pk_add_f32 v[136:137], v[136:137], v[140:141]
    v_pk_add_f32 v[130:131], v[130:131], v[134:135]
    v_pk_add_f32 v[138:139], v[138:139], v[142:143]
    v_pk_add_f32 v[128:129], v[128:129], v[136:137]
    v_pk_add_f32 v[130:131], v[130:131], v[138:139]
    v_bfi_b32 v72, s15, v80, v128
    v_bfi_b32 v73, s15, v81, v129
    v_bfi_b32 v74, s15, v82, v130
    v_bfi_b32 v75, s15, v83, v131
    buffer_store_dwordx4 v[72:75], v244, s[88:91], 0 offen offset:2048 sc1
    s_waitcnt lgkmcnt(0)
    v_pk_add_f32 v[144:145], v[144:145], v[148:149]
    v_pk_add_f32 v[152:153], v[152:153], v[156:157]
    v_pk_add_f32 v[146:147], v[146:147], v[150:151]
    v_pk_add_f32 v[154:155], v[154:155], v[158:159]
    v_pk_add_f32 v[144:145], v[144:145], v[152:153]
    v_pk_add_f32 v[146:147], v[146:147], v[154:155]
    v_bfi_b32 v76, s15, v80, v144
    v_bfi_b32 v77, s15, v81, v145
    v_bfi_b32 v78, s15, v82, v146
    v_bfi_b32 v79, s15, v83, v147
    buffer_store_dwordx4 v[76:79], v244, s[88:91], 0 offen offset:3072 sc1
    v_subrev_u32 v250, 98304, v250
    s_waitcnt vmcnt(22)
    v_mfma_f32_32x32x16_bf16 v[160:175], a[88:91], a[200:203], v[160:175]
    buffer_load_dwordx4 a[196:199], v33, s[88:91], s93 offen offset:1024 sc1
    v_mfma_f32_32x32x16_bf16 v[192:207], a[92:95], a[200:203], v[192:207]
    s_waitcnt vmcnt(22)
    v_mfma_f32_32x32x16_bf16 v[176:191], a[88:91], a[204:207], v[176:191]
    v_mfma_f32_32x32x16_bf16 v[208:223], a[92:95], a[204:207], v[208:223]
    buffer_load_dwordx4 a[200:203], v33, s[88:91], s93 offen offset:2048 sc1
    s_waitcnt vmcnt(22)
    v_mfma_f32_32x32x16_bf16 v[160:175], a[96:99], a[208:211], v[160:175]
    buffer_load_dwordx4 a[204:207], v33, s[88:91], s93 offen offset:3072 sc1
    v_mfma_f32_32x32x16_bf16 v[192:207], a[100:103], a[208:211], v[192:207]
    s_waitcnt vmcnt(22)
    v_mfma_f32_32x32x16_bf16 v[176:191], a[96:99], a[212:215], v[176:191]
    v_mfma_f32_32x32x16_bf16 v[208:223], a[100:103], a[212:215], v[208:223]
    s_waitcnt vmcnt(21)
    v_mfma_f32_32x32x16_bf16 v[160:175], a[104:107], a[216:219], v[160:175]
    v_mfma_f32_32x32x16_bf16 v[192:207], a[108:111], a[216:219], v[192:207]
    s_waitcnt vmcnt(20)
    v_mfma_f32_32x32x16_bf16 v[176:191], a[104:107], a[220:223], v[176:191]
    v_mfma_f32_32x32x16_bf16 v[208:223], a[108:111], a[220:223], v[208:223]
    s_waitcnt vmcnt(19)
    v_mfma_f32_32x32x16_bf16 v[160:175], a[112:115], a[224:227], v[160:175]
    v_mfma_f32_32x32x16_bf16 v[192:207], a[116:119], a[224:227], v[192:207]
    s_waitcnt vmcnt(18)
    v_mfma_f32_32x32x16_bf16 v[176:191], a[112:115], a[228:231], v[176:191]
    v_mfma_f32_32x32x16_bf16 v[208:223], a[116:119], a[228:231], v[208:223]
    s_waitcnt vmcnt(17)
    v_mfma_f32_32x32x16_bf16 v[160:175], a[120:123], a[232:235], v[160:175]
    v_mfma_f32_32x32x16_bf16 v[192:207], a[124:127], a[232:235], v[192:207]
    s_waitcnt vmcnt(16)
    v_mfma_f32_32x32x16_bf16 v[176:191], a[120:123], a[236:239], v[176:191]
    v_mfma_f32_32x32x16_bf16 v[208:223], a[124:127], a[236:239], v[208:223]
    s_waitcnt vmcnt(15)
    v_mfma_f32_32x32x16_bf16 v[160:175], a[128:131], a[240:243], v[160:175]
    v_mfma_f32_32x32x16_bf16 v[192:207], a[132:135], a[240:243], v[192:207]
    s_waitcnt vmcnt(14)
    v_mfma_f32_32x32x16_bf16 v[176:191], a[128:131], a[244:247], v[176:191]
    v_mfma_f32_32x32x16_bf16 v[208:223], a[132:135], a[244:247], v[208:223]
    s_waitcnt vmcnt(13)
    v_mfma_f32_32x32x16_bf16 v[160:175], a[136:139], a[248:251], v[160:175]
    v_mfma_f32_32x32x16_bf16 v[192:207], a[140:143], a[248:251], v[192:207]
    s_waitcnt vmcnt(12)
    v_mfma_f32_32x32x16_bf16 v[176:191], a[136:139], a[252:255], v[176:191]
    v_mfma_f32_32x32x16_bf16 v[208:223], a[140:143], a[252:255], v[208:223]
    s_waitcnt vmcnt(11)
    v_mfma_f32_32x32x16_bf16 v[160:175], a[144:147], a[176:179], v[160:175]
    s_waitcnt vmcnt(9)
    v_mfma_f32_32x32x16_bf16 v[160:175], a[152:155], a[184:187], v[160:175]
    s_waitcnt vmcnt(7)
    v_mfma_f32_32x32x16_bf16 v[160:175], a[160:163], a[192:195], v[160:175]
    s_waitcnt vmcnt(1)
    v_mfma_f32_32x32x16_bf16 v[160:175], a[168:171], a[200:203], v[160:175]
    v_mfma_f32_32x32x16_bf16 v[192:207], a[148:151], a[176:179], v[192:207]
    v_mfma_f32_32x32x16_bf16 v[192:207], a[156:159], a[184:187], v[192:207]
    s_nop 9
    ds_write_b128 v246, v[160:163] offset:0
    v_mfma_f32_32x32x16_bf16 v[192:207], a[164:167], a[192:195], v[192:207]
    ds_write_b128 v247, v[164:167] offset:0
    v_mfma_f32_32x32x16_bf16 v[192:207], a[172:175], a[200:203], v[192:207]
    ds_write_b128 v248, v[168:171] offset:0
    v_mfma_f32_32x32x16_bf16 v[176:191], a[144:147], a[180:183], v[176:191]
    ds_write_b128 v249, v[172:175] offset:0
    v_mfma_f32_32x32x16_bf16 v[176:191], a[152:155], a[188:191], v[176:191]
    s_nop 7
    ds_write_b128 v246, v[192:195] offset:128
    v_mfma_f32_32x32x16_bf16 v[176:191], a[160:163], a[196:199], v[176:191]
    ds_write_b128 v247, v[196:199] offset:128
    s_waitcnt vmcnt(0)
    v_mfma_f32_32x32x16_bf16 v[176:191], a[168:171], a[204:207], v[176:191]
    ds_write_b128 v248, v[200:203] offset:128
    v_mfma_f32_32x32x16_bf16 v[208:223], a[148:151], a[180:183], v[208:223]
    ds_write_b128 v249, v[204:207] offset:128
    v_mfma_f32_32x32x16_bf16 v[208:223], a[156:159], a[188:191], v[208:223]
    s_nop 7
    ds_write_b128 v246, v[176:179] offset:8192
    v_mfma_f32_32x32x16_bf16 v[208:223], a[164:167], a[196:199], v[208:223]
    ds_write_b128 v247, v[180:183] offset:8192
    v_mfma_f32_32x32x16_bf16 v[208:223], a[172:175], a[204:207], v[208:223]
    ds_write_b128 v248, v[184:187] offset:8192
    ds_write_b128 v249, v[188:191] offset:8192
    s_nop 9
    ds_write_b128 v246, v[208:211] offset:8320
    ds_write_b128 v247, v[212:215] offset:8320
    ds_write_b128 v248, v[216:219] offset:8320
    ds_write_b128 v249, v[220:223] offset:8320
    buffer_load_dwordx4 v[40:43], v245, s[88:91], 0 offen offset:0 sc1
    buffer_load_dwordx4 v[44:47], v245, s[88:91], 0 offen offset:1024 sc1
    buffer_load_dwordx4 v[48:51], v245, s[88:91], 0 offen offset:2048 sc1
    buffer_load_dwordx4 v[52:55], v245, s[88:91], 0 offen offset:3072 sc1
    s_waitcnt lgkmcnt(0)
    s_barrier
    ds_read_b128 v[96:99], v250 offset:0
    ds_read_b128 v[100:103], v250 offset:16384
    ds_read_b128 v[104:107], v250 offset:32768
    ds_read_b128 v[108:111], v250 offset:49152
    ds_read_b128 v[112:115], v250 offset:1024
    ds_read_b128 v[116:119], v250 offset:17408
    ds_read_b128 v[120:123], v250 offset:33792
    ds_read_b128 v[124:127], v250 offset:50176
    ds_read_b128 v[128:131], v250 offset:2048
    ds_read_b128 v[132:135], v250 offset:18432
    ds_read_b128 v[136:139], v250 offset:34816
    ds_read_b128 v[140:143], v250 offset:51200
    ds_read_b128 v[144:147], v250 offset:3072
    ds_read_b128 v[148:151], v250 offset:19456
    ds_read_b128 v[152:155], v250 offset:35840
    ds_read_b128 v[156:159], v250 offset:52224
    s_waitcnt lgkmcnt(14)
    v_pk_add_f32 v[96:97], v[96:97], v[2:3]
    v_pk_add_f32 v[98:99], v[98:99], v[4:5]
    v_pk_add_f32 v[96:97], v[96:97], v[100:101]
    v_pk_add_f32 v[98:99], v[98:99], v[102:103]
    s_waitcnt lgkmcnt(12)
    v_pk_add_f32 v[104:105], v[104:105], v[108:109]
    v_pk_add_f32 v[106:107], v[106:107], v[110:111]
    v_pk_add_f32 v[96:97], v[96:97], v[104:105]
    v_pk_add_f32 v[98:99], v[98:99], v[106:107]
    s_waitcnt lgkmcnt(10)
    v_pk_add_f32 v[112:113], v[112:113], v[6:7]
    v_pk_add_f32 v[114:115], v[114:115], v[8:9]
    v_pk_add_f32 v[112:113], v[112:113], v[116:117]
    v_pk_add_f32 v[114:115], v[114:115], v[118:119]
    s_waitcnt lgkmcnt(8)
    v_pk_add_f32 v[120:121], v[120:121], v[124:125]
    v_pk_add_f32 v[122:123], v[122:123], v[126:127]
    v_pk_add_f32 v[112:113], v[112:113], v[120:121]
    v_pk_add_f32 v[114:115], v[114:115], v[122:123]
    s_waitcnt lgkmcnt(6)
    v_pk_add_f32 v[128:129], v[128:129], v[10:11]
    v_pk_add_f32 v[130:131], v[130:131], v[12:13]
    v_pk_add_f32 v[128:129], v[128:129], v[132:133]
    v_pk_add_f32 v[130:131], v[130:131], v[134:135]
    s_waitcnt lgkmcnt(4)
    v_pk_add_f32 v[136:137], v[136:137], v[140:141]
    v_pk_add_f32 v[138:139], v[138:139], v[142:143]
    v_pk_add_f32 v[128:129], v[128:129], v[136:137]
    v_pk_add_f32 v[130:131], v[130:131], v[138:139]
    s_waitcnt lgkmcnt(2)
    v_pk_add_f32 v[144:145], v[144:145], v[14:15]
    v_pk_add_f32 v[146:147], v[146:147], v[16:17]
    v_pk_add_f32 v[144:145], v[144:145], v[148:149]
    v_pk_add_f32 v[146:147], v[146:147], v[150:151]
    s_waitcnt lgkmcnt(0)
    v_pk_add_f32 v[152:153], v[152:153], v[156:157]
    v_pk_add_f32 v[154:155], v[154:155], v[158:159]
    v_pk_add_f32 v[144:145], v[144:145], v[152:153]
    v_pk_add_f32 v[146:147], v[146:147], v[154:155]
    s_waitcnt vmcnt(0)
    s_mov_b32 s13, 0x0c0c0400
    s_mov_b32 s14, 0x05040100
    v_perm_b32 v60, v41, v40, s13
    v_perm_b32 v61, v43, v42, s13
    v_perm_b32 v56, v61, v60, s14
    v_perm_b32 v60, v45, v44, s13
    v_perm_b32 v61, v47, v46, s13
    v_perm_b32 v57, v61, v60, s14
    v_perm_b32 v60, v49, v48, s13
    v_perm_b32 v61, v51, v50, s13
    v_perm_b32 v58, v61, v60, s14
    v_perm_b32 v60, v53, v52, s13
    v_perm_b32 v61, v55, v54, s13
    v_perm_b32 v59, v61, v60, s14
    v_cmp_ne_u32 s[46:47], s96, v56
    v_cmp_ne_u32 vcc, s96, v57
    s_or_b64 s[46:47], s[46:47], vcc
    v_cmp_ne_u32 vcc, s96, v58
    s_or_b64 s[46:47], s[46:47], vcc
    v_cmp_ne_u32 vcc, s96, v59
    s_or_b64 s[46:47], s[46:47], vcc
    s_cbranch_scc1 L_xc_slow
L_xc_ok:
    v_and_b32 v40, 0xffffff00, v40
    v_and_b32 v41, 0xffffff00, v41
    v_and_b32 v42, 0xffffff00, v42
    v_and_b32 v43, 0xffffff00, v43
    s_movk_i32 s13, 0
    v_pk_add_f32 v[96:97], v[96:97], v[40:41]
    v_pk_add_f32 v[98:99], v[98:99], v[42:43]
    buffer_store_dwordx4 v[96:99], v19, s[84:87], s13 offen nt
    v_and_b32 v44, 0xffffff00, v44
    v_and_b32 v45, 0xffffff00, v45
    v_and_b32 v46, 0xffffff00, v46
    v_and_b32 v47, 0xffffff00, v47
    s_movk_i32 s13, 8192
    v_pk_add_f32 v[112:113], v[112:113], v[44:45]
    v_pk_add_f32 v[114:115], v[114:115], v[46:47]
    buffer_store_dwordx4 v[112:115], v19, s[84:87], s13 offen nt
    v_and_b32 v48, 0xffffff00, v48
    v_and_b32 v49, 0xffffff00, v49
    v_and_b32 v50, 0xffffff00, v50
    v_and_b32 v51, 0xffffff00, v51
    s_movk_i32 s13, 16384
    v_pk_add_f32 v[128:129], v[128:129], v[48:49]
    v_pk_add_f32 v[130:131], v[130:131], v[50:51]
    buffer_store_dwordx4 v[128:131], v19, s[84:87], s13 offen nt
    v_and_b32 v52, 0xffffff00, v52
    v_and_b32 v53, 0xffffff00, v53
    v_and_b32 v54, 0xffffff00, v54
    v_and_b32 v55, 0xffffff00, v55
    s_movk_i32 s13, 24576
    v_pk_add_f32 v[144:145], v[144:145], v[52:53]
    v_pk_add_f32 v[146:147], v[146:147], v[54:55]
    buffer_store_dwordx4 v[144:147], v19, s[84:87], s13 offen nt
    s_lshl_b32 s13, s8, 2
    s_or_b32 s13, s13, s4
    s_lshl_b32 s13, s13, 4
    s_or_b32 s13, s13, s7
    s_cmp_eq_u32 s13, 15
    s_cbranch_scc0 L_nobump
    v_mul_u32_u24 v57, 6291456, v1
    s_mov_b64 exec, 3
    buffer_store_dword v0, v57, s[88:91], 0 offen sc1
    s_mov_b64 exec, -1
L_nobump:
L_end:
    s_endpgm
L_ga_slow:
    s_mov_b32 s97, 0x40000
L_ga_loop:
    s_sleep 1
    buffer_load_dwordx3 v[40:42], v210, s[88:91], 0 offen sc1
    s_waitcnt vmcnt(0)
    s_sub_u32 s97, s97, 1
    s_cbranch_scc1 L_ga_ok
    v_cmp_ne_u32 vcc, s96, v42
    s_cmp_lg_u64 vcc, 0
    s_cbranch_scc1 L_ga_loop
    s_branch L_ga_ok
L_lb_slow:
    s_mov_b32 s97, 0x40000
L_lb_loop:
    s_sleep 1
    buffer_load_dwordx3 v[96:98], v238, s[52:55], 0 offen offset:0 sc1
    buffer_load_dwordx3 v[100:102], v238, s[52:55], 0 offen offset:512 sc1
    buffer_load_dwordx3 v[104:106], v238, s[52:55], 0 offen offset:1024 sc1
    buffer_load_dwordx3 v[108:110], v238, s[52:55], 0 offen offset:1536 sc1
    buffer_load_dwordx3 v[112:114], v238, s[52:55], 0 offen offset:2048 sc1
    buffer_load_dwordx3 v[116:118], v238, s[52:55], 0 offen offset:2560 sc1
    buffer_load_dwordx3 v[120:122], v238, s[52:55], 0 offen offset:3072 sc1
    buffer_load_dwordx3 v[124:126], v238, s[52:55], 0 offen offset:3584 sc1
    s_waitcnt vmcnt(0)
    s_sub_u32 s97, s97, 1
    s_cbranch_scc1 L_lb_ok
    v_cmp_eq_u32 s[48:49], s96, v98
    v_cmp_eq_u32 s[50:51], s96, v102
    v_cmp_eq_u32 s[56:57], s96, v106
    v_cmp_eq_u32 s[58:59], s96, v110
    v_cmp_eq_u32 s[60:61], s96, v114
    v_cmp_eq_u32 s[62:63], s96, v118
    v_cmp_eq_u32 s[70:71], s96, v122
    v_cmp_eq_u32 s[46:47], s96, v126
    s_bcnt1_i32_b64 s48, s[48:49]
    s_bcnt1_i32_b64 s50, s[50:51]
    s_bcnt1_i32_b64 s56, s[56:57]
    s_bcnt1_i32_b64 s58, s[58:59]
    s_bcnt1_i32_b64 s60, s[60:61]
    s_bcnt1_i32_b64 s62, s[62:63]
    s_bcnt1_i32_b64 s70, s[70:71]
    s_bcnt1_i32_b64 s46, s[46:47]
    s_add_u32 s48, s48, s50
    s_add_u32 s48, s48, s56
    s_add_u32 s48, s48, s58
    s_add_u32 s48, s48, s60
    s_add_u32 s48, s48, s62
    s_add_u32 s48, s48, s70
    s_add_u32 s48, s48, s46
    s_cmp_lg_u32 s48, s67
    s_cbranch_scc1 L_lb_loop
    s_branch L_lb_ok
L_c2_slow:
    s_mov_b32 s97, 0x40000
L_c2_loop:
    s_sleep 1
    buffer_load_dwordx2 v[220:221], v211, s[88:91], 0 offen sc1
    s_waitcnt vmcnt(0)
    s_sub_u32 s97, s97, 1
    s_cbranch_scc1 L_c2_ok
    v_cmp_ne_u32 vcc, s96, v220
    s_cmp_lg_u64 vcc, 0
    s_cbranch_scc1 L_c2_loop
    s_branch L_c2_ok
L_fa_slow:
    s_mov_b32 s97, 0x40000
L_fa_loop:
    s_sleep 1
    buffer_load_dword v239, v36, s[88:91], 0 offen sc1
    s_waitcnt vmcnt(0)
    s_sub_u32 s97, s97, 1
    s_cbranch_scc1 L_fa_ok
    v_cmp_ne_u32 vcc, s96, v239
    s_and_b32 s46, vcc_lo, 255
    s_cbranch_scc1 L_fa_loop
    s_branch L_fa_ok
L_fs_slow:
    s_mov_b32 s97, 0x40000
L_fs_loop:
    s_sleep 1
    buffer_load_dword v239, v36, s[88:91], 0 offen offset:128 sc1
    s_waitcnt vmcnt(0)
    s_sub_u32 s97, s97, 1
    s_cbranch_scc1 L_fs_ok
    v_cmp_ne_u32 vcc, s96, v239
    s_and_b32 s46, vcc_lo, 65535
    s_cbranch_scc1 L_fs_loop
    s_branch L_fs_ok
L_xc_slow:
    s_mov_b32 s97, 0x40000
L_xc_loop:
    s_sleep 1
    buffer_load_dwordx4 v[40:43], v245, s[88:91], 0 offen offset:0 sc1
    buffer_load_dwordx4 v[44:47], v245, s[88:91], 0 offen offset:1024 sc1
    buffer_load_dwordx4 v[48:51], v245, s[88:91], 0 offen offset:2048 sc1
    buffer_load_dwordx4 v[52:55], v245, s[88:91], 0 offen offset:3072 sc1
    s_waitcnt vmcnt(0)
    s_sub_u32 s97, s97, 1
    s_cbranch_scc1 L_xc_ok
    s_mov_b32 s13, 0x0c0c0400
    s_mov_b32 s14, 0x05040100
    v_perm_b32 v60, v41, v40, s13
    v_perm_b32 v61, v43, v42, s13
    v_perm_b32 v56, v61, v60, s14
    v_perm_b32 v60, v45, v44, s13
    v_perm_b32 v61, v47, v46, s13
    v_perm_b32 v57, v61, v60, s14
    v_perm_b32 v60, v49, v48, s13
    v_perm_b32 v61, v51, v50, s13
    v_perm_b32 v58, v61, v60, s14
    v_perm_b32 v60, v53, v52, s13
    v_perm_b32 v61, v55, v54, s13
    v_perm_b32 v59, v61, v60, s14
    v_cmp_ne_u32 s[46:47], s96, v56
    v_cmp_ne_u32 vcc, s96, v57
    s_or_b64 s[46:47], s[46:47], vcc
    v_cmp_ne_u32 vcc, s96, v58
    s_or_b64 s[46:47], s[46:47], vcc
    v_cmp_ne_u32 vcc, s96, v59
    s_or_b64 s[46:47], s[46:47], vcc
    s_cbranch_scc1 L_xc_loop
    s_branch L_xc_ok
L_fin:
.section .rodata,"a"
.p2align 6
.amdhsa_kernel parallel_sum__ssm_conv_s5__dense_activation_relu__prompt_kernel
  .amdhsa_next_free_vgpr 512
  .amdhsa_next_free_sgpr 102
  .amdhsa_accum_offset 256
  .amdhsa_group_segment_fixed_size 0
  .amdhsa_kernarg_size 120
  .amdhsa_user_sgpr_count 2
  .amdhsa_user_sgpr_kernarg_segment_ptr 1
  .amdhsa_system_sgpr_workgroup_id_x 1
.end_amdhsa_kernel
```
